```python
import torch

def _softmax(x, axis=-1):
    return torch.softmax(x, dim=axis)
def _gelu(x):
    return torch.nn.functional.gelu(x, approximate="tanh")
def _silu(x):
    return torch.nn.functional.silu(x)
def _sigmoid(x):
    return torch.sigmoid(x)
def _layernorm(x, axis=-1, eps=1e-5):
    m = x.mean(dim=axis, keepdim=True)
    v = x.var(dim=axis, keepdim=True, unbiased=False)
    return (x - m) / torch.sqrt(v + eps)
def _scatter_add(tgt, idx, src, axis=0):
    return tgt.clone().index_add_(axis, idx, src)
def _segment_sum(src, seg, n):
    out = torch.zeros((n,) + src.shape[1:], dtype=src.dtype)
    return out.index_add_(0, seg, src)
def _pad(x, pw):
    flat = tuple(v for pair in reversed(pw) for v in pair)
    return torch.nn.functional.pad(x, flat)

kernel_name = 'parallel_sum__ssm_conv_s4__dense_activation_gelu__prompt'

def setup_inputs():

    _w = (lambda a: (lambda t: t.to(torch.bfloat16) if t.is_floating_point() else t)(torch.as_tensor(a)))
    def _A_setup():
        B, L, D, N = 1, 2048, 576, 128
        A_re = -(lambda _x: torch.exp(torch.as_tensor(_x)))((lambda *s: torch.randn(*s, dtype=torch.bfloat16) * 6.4)(D, N))
        A_im = torch.pi * (lambda *s: torch.randn(*s, dtype=torch.bfloat16) * 0.05)(D, N)
        B_re = (lambda *s: torch.randn(*s, dtype=torch.bfloat16) * 0.1)(D, N)
        B_im = (lambda *s: torch.randn(*s, dtype=torch.bfloat16) * 0.1)(D, N)
        C_re = (lambda *s: torch.randn(*s, dtype=torch.bfloat16) * 0.1)(D, N)
        C_im = (lambda *s: torch.randn(*s, dtype=torch.bfloat16) * 0.1)(D, N)
        log_dt = (lambda *s: torch.randn(*s, dtype=torch.bfloat16) * 0.05)(D) * 0.5 - 4.0
        Dskip = (lambda *s: torch.randn(*s, dtype=torch.bfloat16) * 0.05)(D)
        return {
            "u": _w((lambda *s: torch.randn(*s, dtype=torch.bfloat16) * 0.05)(B, L, D)),
            "A_re": _w(A_re),
            "A_im": _w(A_im),
            "B_re": _w(B_re),
            "B_im": _w(B_im),
            "C_re": _w(C_re),
            "C_im": _w(C_im),
            "log_dt": _w(log_dt),
            "Dskip": _w(Dskip),
        }
    _A_in = _A_setup()

    def _B_setup():
        B, S, D, F = 1, 2048, 576, 4608
        return {
            "x": _w((lambda *s: torch.randn(*s, dtype=torch.bfloat16) * 0.05)(B, S, D)),
            "w1": _w((lambda *s: torch.randn(*s, dtype=torch.bfloat16) * 0.8)(D, F) * (D ** -0.5)),
            "b1": _w((lambda *s: torch.randn(*s, dtype=torch.bfloat16) * 0.2)(F) * 0.01),
            "w2": _w((lambda *s: torch.randn(*s, dtype=torch.bfloat16) * 0.2)(F, D) * (F ** -0.5)),
            "b2": _w((lambda *s: torch.randn(*s, dtype=torch.bfloat16) * 0.2)(D) * 0.01),
        }
    _B_in = _B_setup()

    return {
        "A_u": _A_in["u"],
        "A_A_re": _A_in["A_re"],
        "A_A_im": _A_in["A_im"],
        "A_B_re": _A_in["B_re"],
        "A_B_im": _A_in["B_im"],
        "A_C_re": _A_in["C_re"],
        "A_C_im": _A_in["C_im"],
        "A_log_dt": _A_in["log_dt"],
        "A_Dskip": _A_in["Dskip"],
        "B_x": _B_in["x"],
        "B_w1": _B_in["w1"],
        "B_b1": _B_in["b1"],
        "B_w2": _B_in["w2"],
        "B_b2": _B_in["b2"],
    }

def reference(A_u, A_A_re, A_A_im, A_B_re, A_B_im, A_C_re, A_C_im, A_log_dt, A_Dskip, B_x, B_w1, B_b1, B_w2, B_b2):
    def _A_ref(u, A_re, A_im, B_re, B_im, C_re, C_im, log_dt, Dskip):
        Bsz, L, D = u.shape
        dt = torch.exp(log_dt)[:, None]
        A = A_re + 1j * A_im
        Bc = B_re + 1j * B_im
        Cc = C_re + 1j * C_im
        logdA = dt * A
        dB = dt * Bc
        l = (lambda x, dt: x.to(dt))(torch.arange(L), A_re.dtype)
        P = torch.exp(logdA[:, :, None] * l[None, None, :])
        K = torch.einsum("dn,dnl,dn->dl", Cc, P, dB).real
        L2 = 2 * L
        Kp = _pad(K, ((0, 0), (0, L)))
        up = (lambda x, *d: x.permute(*d))(u, 0, 2, 1)
        up = _pad(up, ((0, 0), (0, 0), (0, L)))
        Kf = (lambda x, axes=(-2,-1): torch.fft.rfft2(x.float(), dim=axes))(Kp[:, None, :], axes=(-2, -1))
        Uf = (lambda x, axes=(-2,-1): torch.fft.rfft2(x.float(), dim=axes))(up[:, :, None, :], axes=(-2, -1))
        Yf = Uf * Kf[None, :, :, :]
        y = (lambda x, s, axes=(-2,-1): torch.fft.irfft2(x, s=s, dim=axes).to(torch.bfloat16))(Yf, (1, L2), axes=(-2, -1))[:, :, 0, :L]
        y = (lambda x, *d: x.permute(*d))(y, 0, 2, 1) + u * Dskip[None, None, :]
        return y

    def _B_ref(x, w1, b1, w2, b2):
        h = torch.einsum("bsd,df->bsf", x, w1) + b1
        h = _gelu(h)
        return torch.einsum("bsf,fd->bsd", h, w2) + b2

    x = A_u
    xn = _layernorm(x, axis=-1)
    return x + _A_ref(xn, A_A_re, A_A_im, A_B_re, A_B_im, A_C_re, A_C_im, A_log_dt, A_Dskip) + _B_ref(xn, B_w1, B_b1, B_w2, B_b2)
```

```asm
; @launch kernel=mlp_kernel grid=(256,1,1) block=(512,1,1) lds=163840
; @launch kernel=ssm_kernel grid=(144,1,1) block=(1024,1,1) lds=163840
.amdgcn_target "amdgcn-amd-amdhsa--gfx950"
.text
.globl mlp_kernel
.p2align 8
.type mlp_kernel,@function
mlp_kernel:
    s_cmp_ge_u32 s2, 256
    s_cbranch_scc1 K1_END
    s_load_dwordx2 s[4:5], s[0:1], 0
    s_load_dwordx4 s[48:51], s[0:1], 80
    s_load_dwordx2 s[12:13], s[0:1], 96
    s_load_dwordx2 s[16:17], s[0:1], 128
    s_load_dwordx16 s[84:99], s[0:1], 8
    v_lshrrev_b32 v34, 6, v0
    v_and_b32 v1, 63, v0
    v_readfirstlane_b32 s24, v34
    v_lshrrev_b32 v2, 4, v1
    v_and_b32 v3, 15, v1
    s_and_b32 s3, s2, 7
    s_lshr_b32 s28, s2, 3
    s_and_b32 s27, s28, 3
    s_lshr_b32 s38, s3, 1
    s_lshl_b32 s38, s38, 2
    s_add_u32 s27, s27, s38
    s_lshr_b32 s28, s28, 2
    s_and_b32 s3, s3, 1
    s_lshl_b32 s3, s3, 3
    s_add_u32 s28, s28, s3
    s_lshr_b32 s25, s24, 2
    s_and_b32 s26, s24, 3
    s_mov_b32 s43, 0x3f803f80
    s_mov_b32 s44, 0xffff0000
    s_mov_b32 s47, 0x3eeff558
    v_lshrrev_b32 v36, 3, v1
    v_and_b32 v37, 7, v1
    v_xor_b32 v38, v2, v37
    v_mul_u32_u24 v39, 2304, v36
    v_lshl_add_u32 v34, v38, 4, v39
    v_xor_b32 v35, 64, v34
    s_lshl_b32 s40, s28, 7
    s_lshr_b32 s38, s24, 1
    s_lshl_b32 s38, s38, 5
    s_add_u32 s40, s40, s38
    s_and_b32 s38, s24, 1
    s_add_u32 s40, s40, s38
    s_mul_i32 s40, s40, 1152
    s_lshl_b32 s41, s24, 11
    v_subrev_u32 v43, 192, v0
    v_min_u32 v43, 287, v43
    v_lshlrev_b32 v43, 7, v43
    s_and_b32 s45, s27, 3
    s_mul_i32 s45, s45, 36864
    s_mul_i32 s46, s28, 147456
    s_add_u32 s45, s45, s46
    s_getpc_b64 s[52:53]
    s_lshl_b32 s46, s25, 6
    v_add_u32 v44, s46, v1
    s_waitcnt lgkmcnt(0)
    s_mov_b32 s6, 2359296
    s_mov_b32 s7, 0x00020000
    s_mov_b32 s8, s48
    s_mov_b32 s9, s49
    s_mov_b32 s10, 5308416
    s_mov_b32 s11, 0x00020000
    s_mov_b32 s14, 5308416
    s_mov_b32 s15, 0x00020000
    s_mov_b32 s18, 268435456
    s_mov_b32 s19, 0x00020000
    s_mov_b32 s20, s50
    s_mov_b32 s21, s51
    s_mov_b32 s22, 9216
    s_mov_b32 s23, 0x00020000
    s_lshl_b32 s83, s28, 4
    s_add_u32 s83, s83, s27
    s_mul_i32 s83, s83, 3
    s_add_u32 s83, s83, s24
    s_cmp_lt_u32 s28, 12
    s_cselect_b32 s82, 1, 0
    s_sub_u32 s3, s24, 4
    s_cmp_lt_u32 s3, 3
    s_cselect_b32 s55, s82, 0
    s_cmp_lt_u32 s24, 3
    s_cselect_b32 s82, s82, 0
    s_cmp_eq_u32 s82, 0
    s_cbranch_scc1 K1_KG0
    s_lshl_b32 s3, s83, 8
    v_lshlrev_b32 v232, 2, v1
    v_add_u32 v232, s3, v232
    global_load_dword v202, v232, s[84:85]
    global_load_dword v203, v232, s[86:87]
    global_load_dword v204, v232, s[88:89]
    global_load_dword v205, v232, s[90:91]
    global_load_dword v206, v232, s[92:93]
    global_load_dword v207, v232, s[94:95]
    s_lshr_b32 s3, s83, 1
    s_lshl_b32 s3, s3, 2
    s_load_dword s100, s[96:97], s3
    s_load_dword s101, s[98:99], s3
K1_KG0:
    s_barrier
    s_cmp_lt_u32 s24, 3
    s_cbranch_scc1 K1_PF_2
    s_cmp_eq_u32 s26, 3
    s_cbranch_scc0 K1_PF_1
    v_add_u32 v45, 0, v44
    v_min_u32 v45, ((K1_END - mlp_kernel - 1024) / 128), v45
    v_lshlrev_b32 v46, 7, v45
    global_load_dword v42, v46, s[52:53]
    v_add_u32 v45, 128, v44
    v_min_u32 v45, ((K1_END - mlp_kernel - 1024) / 128), v45
    v_lshlrev_b32 v47, 7, v45
    global_load_dword v42, v47, s[52:53]
    v_add_u32 v45, 256, v44
    v_min_u32 v45, ((K1_END - mlp_kernel - 1024) / 128), v45
    v_lshlrev_b32 v48, 7, v45
    global_load_dword v42, v48, s[52:53]
K1_PF_1:
    buffer_load_dword v42, v43, s[4:7], s45 offen
K1_PF_2:
    s_setprio 3
    s_cmp_eq_u32 s55, 0
    s_cbranch_scc1 K1_XD_3
    s_add_u32 m0, s41, -8192
    s_add_u32 s38, s40, -73728
    buffer_load_dwordx4 v34, s[4:7], s38 offen lds
    s_add_u32 m0, s41, -7168
    s_add_u32 s38, s40, -55296
    buffer_load_dwordx4 v35, s[4:7], s38 offen lds
    s_add_u32 m0, s41, 8192
    s_add_u32 s38, s40, -73600
    buffer_load_dwordx4 v34, s[4:7], s38 offen lds
    s_add_u32 m0, s41, 9216
    s_add_u32 s38, s40, -55168
    buffer_load_dwordx4 v35, s[4:7], s38 offen lds
    s_add_u32 m0, s41, 24576
    s_add_u32 s38, s40, -73472
    buffer_load_dwordx4 v34, s[4:7], s38 offen lds
    s_add_u32 m0, s41, 25600
    s_add_u32 s38, s40, -55040
    buffer_load_dwordx4 v35, s[4:7], s38 offen lds
K1_XD_3:
    s_cmp_eq_u32 s82, 1
    s_cbranch_scc1 K1_XD_4
    s_add_u32 m0, s41, 0
    s_add_u32 s38, s40, 0
    buffer_load_dwordx4 v34, s[4:7], s38 offen lds
    s_add_u32 m0, s41, 1024
    s_add_u32 s38, s40, 18432
    buffer_load_dwordx4 v35, s[4:7], s38 offen lds
    s_add_u32 m0, s41, 16384
    s_add_u32 s38, s40, 128
    buffer_load_dwordx4 v34, s[4:7], s38 offen lds
    s_add_u32 m0, s41, 17408
    s_add_u32 s38, s40, 18560
    buffer_load_dwordx4 v35, s[4:7], s38 offen lds
    s_add_u32 m0, s41, 32768
    s_add_u32 s38, s40, 256
    buffer_load_dwordx4 v34, s[4:7], s38 offen lds
    s_add_u32 m0, s41, 33792
    s_add_u32 s38, s40, 18688
    buffer_load_dwordx4 v35, s[4:7], s38 offen lds
K1_XD_4:
    s_setprio 0
    s_and_b32 s39, s27, 1
    s_mul_i32 s42, s27, 576
    s_add_u32 s46, s26, 8
    s_mul_i32 s29, s24, 73728
    s_mul_i32 s30, s46, 73728
    s_lshl_b32 s45, s39, 6
    s_add_u32 s45, s45, s42
    s_lshl_b32 s38, s39, 9
    s_sub_u32 s38, 512, s38
    s_add_u32 s38, s38, s42
    s_add_u32 s31, s29, s38
    s_add_u32 s32, s30, s38
    s_add_u32 s29, s29, s45
    s_add_u32 s30, s30, s45
    s_mul_i32 s38, s25, 884736
    s_add_u32 s48, s30, s38
    s_mul_i32 s38, s25, 1769472
    s_add_u32 s49, s32, s38
    s_lshr_b32 s33, s24, 2
    s_lshl_b32 s33, s33, 5
    s_and_b32 s45, s24, 1
    s_lshl_b32 s45, s45, 4
    s_add_u32 s33, s33, s45
    s_and_b32 s45, s24, 2
    s_lshl_b32 s45, s45, 2
    s_add_u32 s33, s33, s45
    s_lshr_b32 s35, s46, 2
    s_lshl_b32 s35, s35, 5
    s_and_b32 s45, s46, 1
    s_lshl_b32 s45, s45, 4
    s_add_u32 s35, s35, s45
    s_and_b32 s45, s46, 2
    s_lshl_b32 s45, s45, 2
    s_add_u32 s35, s35, s45
    s_mul_i32 s38, s27, 288
    s_lshl_b32 s45, s39, 5
    s_add_u32 s38, s38, s45
    s_sub_u32 s38, s38, 32
    s_add_u32 s33, s33, s38
    s_add_u32 s35, s35, s38
    s_or_b32 s45, s39, s25
    s_cmp_eq_u32 s45, 0
    s_cselect_b32 s45, 288, 0
    s_add_u32 s34, s33, s45
    s_mul_i32 s33, s33, 1152
    s_mul_i32 s35, s35, 1152
    s_mul_i32 s34, s34, 1152
    s_lshl_b32 s36, s24, 10
    s_lshl_b32 s37, s46, 10
    s_mul_i32 s38, s25, 12288
    s_add_u32 s50, s37, s38
    s_setprio 2
    s_cmp_eq_u32 s55, 0
    s_cbranch_scc1 K1_XD_5
    s_add_u32 m0, s41, 40960
    s_add_u32 s38, s40, -73344
    buffer_load_dwordx4 v34, s[4:7], s38 offen lds
    s_add_u32 m0, s41, 41984
    s_add_u32 s38, s40, -54912
    buffer_load_dwordx4 v35, s[4:7], s38 offen lds
    s_add_u32 m0, s41, 57344
    s_add_u32 s38, s40, -73216
    buffer_load_dwordx4 v34, s[4:7], s38 offen lds
    s_add_u32 m0, s41, 58368
    s_add_u32 s38, s40, -54784
    buffer_load_dwordx4 v35, s[4:7], s38 offen lds
    s_add_u32 m0, s41, 73728
    s_add_u32 s38, s40, -73088
    buffer_load_dwordx4 v34, s[4:7], s38 offen lds
    s_add_u32 m0, s41, 74752
    s_add_u32 s38, s40, -54656
    buffer_load_dwordx4 v35, s[4:7], s38 offen lds
K1_XD_5:
    s_cmp_eq_u32 s82, 1
    s_cbranch_scc1 K1_XD_6
    s_add_u32 m0, s41, 49152
    s_add_u32 s38, s40, 384
    buffer_load_dwordx4 v34, s[4:7], s38 offen lds
    s_add_u32 m0, s41, 50176
    s_add_u32 s38, s40, 18816
    buffer_load_dwordx4 v35, s[4:7], s38 offen lds
    s_add_u32 m0, s41, 65536
    s_add_u32 s38, s40, 512
    buffer_load_dwordx4 v34, s[4:7], s38 offen lds
    s_add_u32 m0, s41, 66560
    s_add_u32 s38, s40, 18944
    buffer_load_dwordx4 v35, s[4:7], s38 offen lds
    s_add_u32 m0, s41, 81920
    s_add_u32 s38, s40, 640
    buffer_load_dwordx4 v34, s[4:7], s38 offen lds
    s_add_u32 m0, s41, 82944
    s_add_u32 s38, s40, 19072
    buffer_load_dwordx4 v35, s[4:7], s38 offen lds
K1_XD_6:
    s_setprio 0
    v_and_b32 v38, 1, v2
    v_lshlrev_b32 v38, 2, v38
    v_xor_b32 v38, v38, v37
    v_mul_u32_u24 v44, 9216, v36
    v_lshl_add_u32 v13, v38, 4, v44
    v_lshrrev_b32 v45, 2, v38
    v_mul_u32_u24 v45, 884736, v45
    v_and_b32 v38, 3, v38
    v_lshlrev_b32 v38, 4, v38
    v_add3_u32 v14, v38, v44, v45
    v_lshlrev_b32 v38, 1, v2
    v_xor_b32 v38, v38, v37
    v_mul_u32_u24 v44, 1152, v36
    v_lshl_add_u32 v15, v38, 4, v44
    v_lshrrev_b32 v38, 2, v3
    v_and_b32 v44, 3, v1
    v_lshlrev_b32 v44, 3, v44
    v_lshrrev_b32 v39, 1, v2
    v_lshl_add_u32 v43, v39, 3, v38
    v_lshl_add_u32 v43, v43, 7, v44
    v_lshrrev_b32 v45, 1, v38
    v_xor_b32 v45, s25, v45
    v_lshl_add_u32 v43, v45, 6, v43
    v_and_b32 v45, 1, v2
    v_lshl_add_u32 v8, v45, 5, v43
    s_mul_i32 s45, s25, 12288
    s_sub_u32 s46, 12288, s45
    v_add_u32 v4, s45, v8
    v_add_u32 v6, s46, v8
    v_add_u32 v5, 49152, v4
    v_add_u32 v7, 49152, v6
    v_lshl_add_u32 v43, v2, 2, v38
    v_lshl_add_u32 v44, v43, 7, v44
    v_bfe_u32 v43, v43, 1, 2
    s_lshl_b32 s38, s25, 1
    v_xor_b32 v43, s38, v43
    v_lshl_add_u32 v9, v43, 5, v44
    v_xor_b32 v11, 32, v9
    v_add_u32 v10, 49152, v9
    v_add_u32 v12, 49152, v11
    s_lshl_b32 s38, s26, 11
    s_add_u32 s38, s38, 98304
    v_lshlrev_b32 v45, 4, v1
    v_add_u32 v45, s38, v45
    s_lshl_b32 s45, s25, 13
    v_add_u32 v16, s45, v45
    v_xor_b32 v21, 8192, v16
    s_lshl_b32 s45, s25, 10
    v_add_u32 v25, s45, v45
    s_lshl_b32 s45, s25, 14
    v_add_u32 v24, s45, v45
    v_lshlrev_b32 v43, 9, v2
    v_lshl_add_u32 v43, v3, 4, v43
    v_add_u32 v17, s38, v43
    v_lshlrev_b32 v43, 4, v39
    v_add_u32 v19, 158720, v43
    s_lshl_b32 s45, s25, 7
    v_add_u32 v18, s45, v19
    s_mul_i32 s38, s27, 144
    s_lshl_b32 s45, s25, 3
    s_add_u32 s38, s38, s45
    s_lshl_b32 s38, s38, 14
    s_lshl_b32 s45, s28, 10
    s_add_u32 s38, s38, s45
    s_lshl_b32 s45, s26, 8
    s_add_u32 s38, s38, s45
    v_lshlrev_b32 v20, 14, v2
    v_lshl_add_u32 v20, v3, 4, v20
    v_add_u32 v20, s38, v20
    s_setprio 1
    s_cmp_eq_u32 s55, 0
    s_cbranch_scc1 K1_XD_7
    s_add_u32 m0, s41, 90112
    s_add_u32 s38, s40, -72960
    buffer_load_dwordx4 v34, s[4:7], s38 offen lds
    s_add_u32 m0, s41, 91136
    s_add_u32 s38, s40, -54528
    buffer_load_dwordx4 v35, s[4:7], s38 offen lds
    s_add_u32 m0, s41, 106496
    s_add_u32 s38, s40, -72832
    buffer_load_dwordx4 v34, s[4:7], s38 offen lds
    s_add_u32 m0, s41, 107520
    s_add_u32 s38, s40, -54400
    buffer_load_dwordx4 v35, s[4:7], s38 offen lds
    s_add_u32 m0, s41, 122880
    s_add_u32 s38, s40, -72704
    buffer_load_dwordx4 v34, s[4:7], s38 offen lds
    s_add_u32 m0, s41, 123904
    s_add_u32 s38, s40, -54272
    buffer_load_dwordx4 v35, s[4:7], s38 offen lds
K1_XD_7:
    s_cmp_eq_u32 s82, 1
    s_cbranch_scc1 K1_XD_8
    s_add_u32 m0, s41, 98304
    s_add_u32 s38, s40, 768
    buffer_load_dwordx4 v34, s[4:7], s38 offen lds
    s_add_u32 m0, s41, 99328
    s_add_u32 s38, s40, 19200
    buffer_load_dwordx4 v35, s[4:7], s38 offen lds
    s_add_u32 m0, s41, 114688
    s_add_u32 s38, s40, 896
    buffer_load_dwordx4 v34, s[4:7], s38 offen lds
    s_add_u32 m0, s41, 115712
    s_add_u32 s38, s40, 19328
    buffer_load_dwordx4 v35, s[4:7], s38 offen lds
    s_add_u32 m0, s41, 131072
    s_add_u32 s38, s40, 1024
    buffer_load_dwordx4 v34, s[4:7], s38 offen lds
    s_add_u32 m0, s41, 132096
    s_add_u32 s38, s40, 19456
    buffer_load_dwordx4 v35, s[4:7], s38 offen lds
K1_XD_8:
    s_setprio 0
    s_cmp_eq_u32 s82, 0
    s_cbranch_scc1 K1_KG_9
    v_lshlrev_b32 v234, 1, v3
    v_add_u32 v234, 240, v234
    v_cmp_gt_u32 vcc, 8, v3
    s_mov_b32 s84, 0x800200
    s_mov_b32 s85, 0x6000500
    v_lshlrev_b32 v235, 4, v3
    v_cndmask_b32 v234, v234, v3, vcc
    v_lshrrev_b64 v[236:237], v235, s[84:85]
    v_cmp_le_u32 vcc, 12, v3
    v_and_b32 v236, 0xffff, v236
    v_lshlrev_b32 v235, 3, v3
    v_cndmask_b32 v234, v234, v236, vcc
    v_cvt_f32_u32 v201, v235
    v_cvt_f32_u32 v200, v234
    s_waitcnt lgkmcnt(0)
    s_and_b32 s3, s83, 1
    s_lshl_b32 s3, s3, 4
    s_lshr_b32 s100, s100, s3
    s_lshl_b32 s100, s100, 16
    s_lshr_b32 s101, s101, s3
    s_lshl_b32 s101, s101, 16
    v_mov_b32 v234, 0x3fb8aa3b
    v_mul_f32 v234, s100, v234
    v_exp_f32 v234, v234
    s_nop 0
    v_cvt_pk_bf16_f32 v234, v234, v234
    v_and_b32 v234, s44, v234
    v_mul_f32 v235, 0x3fb8aa3b, v234
    v_mul_f32 v236, 0x3e22f983, v234
    s_waitcnt vmcnt(0)
    v_lshlrev_b32 v237, 16, v202
    v_lshlrev_b32 v238, 16, v203
    v_lshlrev_b32 v239, 16, v204
    v_lshlrev_b32 v240, 16, v205
    v_lshlrev_b32 v241, 16, v206
    v_lshlrev_b32 v242, 16, v207
    v_mul_f32 v152, v235, v237
    v_mul_f32 v153, v236, v238
    v_mul_f32 v239, v234, v239
    v_mul_f32 v240, v234, v240
    v_rndne_f32 v243, v153
    v_mul_f32 v154, v241, v239
    v_mul_f32 v155, v241, v240
    v_sub_f32 v153, v153, v243
    v_fma_f32 v154, -v242, v240, v154
    v_fmac_f32 v155, v242, v239
    v_and_b32 v237, s44, v202
    v_and_b32 v238, s44, v203
    v_and_b32 v239, s44, v204
    v_and_b32 v240, s44, v205
    v_and_b32 v241, s44, v206
    v_and_b32 v242, s44, v207
    v_mul_f32 v156, v235, v237
    v_mul_f32 v157, v236, v238
    v_mul_f32 v239, v234, v239
    v_mul_f32 v240, v234, v240
    v_rndne_f32 v243, v157
    v_mul_f32 v158, v241, v239
    v_mul_f32 v159, v241, v240
    v_sub_f32 v157, v157, v243
    v_fma_f32 v158, -v242, v240, v158
    v_fmac_f32 v159, v242, v239
    s_nop 1
    v_mul_f32_dpp v235, v153, v200 row_newbcast:0 row_mask:0xf bank_mask:0xf
    v_mul_f32_dpp v234, v152, v200 row_newbcast:0 row_mask:0xf bank_mask:0xf
    v_mul_f32_dpp v238, v153, v201 row_newbcast:0 row_mask:0xf bank_mask:0xf
    v_mul_f32_dpp v237, v152, v201 row_newbcast:0 row_mask:0xf bank_mask:0xf
    v_fract_f32 v235, v235
    v_exp_f32 v234, v234
    v_cos_f32 v236, v235
    v_sin_f32 v235, v235
    v_exp_f32 v237, v237
    v_mul_f32 v236, v234, v236
    v_cos_f32 v239, v238
    v_mul_f32 v235, v234, v235
    v_sin_f32 v238, v238
    v_mul_f32_dpp v232, v154, v237 row_newbcast:0 row_mask:0xf bank_mask:0xf
    v_mul_f32_dpp v233, v155, v237 row_newbcast:0 row_mask:0xf bank_mask:0xf
    v_cvt_pk_bf16_f32 v184, v236, v235
    v_mul_f32_dpp v240, v236, v236 row_newbcast:12 row_mask:0xf bank_mask:0xf
    v_mul_f32_dpp v241, v235, v236 row_newbcast:12 row_mask:0xf bank_mask:0xf
    v_mul_f32 v242, v232, v239
    v_mul_f32 v243, v232, v238
    v_fmac_f32_dpp v240, -v235, v235 row_newbcast:12 row_mask:0xf bank_mask:0xf
    v_fmac_f32_dpp v241, v236, v235 row_newbcast:12 row_mask:0xf bank_mask:0xf
    v_fma_f32 v242, -v233, v238, v242
    v_fmac_f32 v243, v233, v239
    v_cvt_pk_bf16_f32 v188, v240, v241
    v_mul_f32_dpp v234, v236, v242 row_newbcast:13 row_mask:0xf bank_mask:0xf
    v_mul_f32_dpp v237, v235, v242 row_newbcast:13 row_mask:0xf bank_mask:0xf
    v_cvt_pk_bf16_f32 v192, v242, -v243
    v_fmac_f32_dpp v234, -v235, v243 row_newbcast:13 row_mask:0xf bank_mask:0xf
    v_fmac_f32_dpp v237, v236, v243 row_newbcast:13 row_mask:0xf bank_mask:0xf
    v_cvt_pk_bf16_f32 v196, v234, -v237
    v_mul_f32_dpp v235, v153, v200 row_newbcast:1 row_mask:0xf bank_mask:0xf
    v_mul_f32_dpp v234, v152, v200 row_newbcast:1 row_mask:0xf bank_mask:0xf
    v_mul_f32_dpp v238, v153, v201 row_newbcast:1 row_mask:0xf bank_mask:0xf
    v_mul_f32_dpp v237, v152, v201 row_newbcast:1 row_mask:0xf bank_mask:0xf
    v_fract_f32 v235, v235
    v_exp_f32 v234, v234
    v_cos_f32 v236, v235
    v_sin_f32 v235, v235
    v_exp_f32 v237, v237
    v_mul_f32 v236, v234, v236
    v_cos_f32 v239, v238
    v_mul_f32 v235, v234, v235
    v_sin_f32 v238, v238
    v_mul_f32_dpp v232, v154, v237 row_newbcast:1 row_mask:0xf bank_mask:0xf
    v_mul_f32_dpp v233, v155, v237 row_newbcast:1 row_mask:0xf bank_mask:0xf
    v_cvt_pk_bf16_f32 v185, v236, v235
    v_mul_f32_dpp v240, v236, v236 row_newbcast:12 row_mask:0xf bank_mask:0xf
    v_mul_f32_dpp v241, v235, v236 row_newbcast:12 row_mask:0xf bank_mask:0xf
    v_mul_f32 v242, v232, v239
    v_mul_f32 v243, v232, v238
    v_fmac_f32_dpp v240, -v235, v235 row_newbcast:12 row_mask:0xf bank_mask:0xf
    v_fmac_f32_dpp v241, v236, v235 row_newbcast:12 row_mask:0xf bank_mask:0xf
    v_fma_f32 v242, -v233, v238, v242
    v_fmac_f32 v243, v233, v239
    v_cvt_pk_bf16_f32 v189, v240, v241
    v_mul_f32_dpp v234, v236, v242 row_newbcast:13 row_mask:0xf bank_mask:0xf
    v_mul_f32_dpp v237, v235, v242 row_newbcast:13 row_mask:0xf bank_mask:0xf
    v_cvt_pk_bf16_f32 v193, v242, -v243
    v_fmac_f32_dpp v234, -v235, v243 row_newbcast:13 row_mask:0xf bank_mask:0xf
    v_fmac_f32_dpp v237, v236, v243 row_newbcast:13 row_mask:0xf bank_mask:0xf
    v_cvt_pk_bf16_f32 v197, v234, -v237
    v_mul_f32_dpp v235, v153, v200 row_newbcast:2 row_mask:0xf bank_mask:0xf
    v_mul_f32_dpp v234, v152, v200 row_newbcast:2 row_mask:0xf bank_mask:0xf
    v_mul_f32_dpp v238, v153, v201 row_newbcast:2 row_mask:0xf bank_mask:0xf
    v_mul_f32_dpp v237, v152, v201 row_newbcast:2 row_mask:0xf bank_mask:0xf
    v_fract_f32 v235, v235
    v_exp_f32 v234, v234
    v_cos_f32 v236, v235
    v_sin_f32 v235, v235
    v_exp_f32 v237, v237
    v_mul_f32 v236, v234, v236
    v_cos_f32 v239, v238
    v_mul_f32 v235, v234, v235
    v_sin_f32 v238, v238
    v_mul_f32_dpp v232, v154, v237 row_newbcast:2 row_mask:0xf bank_mask:0xf
    v_mul_f32_dpp v233, v155, v237 row_newbcast:2 row_mask:0xf bank_mask:0xf
    v_cvt_pk_bf16_f32 v186, v236, v235
    v_mul_f32_dpp v240, v236, v236 row_newbcast:12 row_mask:0xf bank_mask:0xf
    v_mul_f32_dpp v241, v235, v236 row_newbcast:12 row_mask:0xf bank_mask:0xf
    v_mul_f32 v242, v232, v239
    v_mul_f32 v243, v232, v238
    v_fmac_f32_dpp v240, -v235, v235 row_newbcast:12 row_mask:0xf bank_mask:0xf
    v_fmac_f32_dpp v241, v236, v235 row_newbcast:12 row_mask:0xf bank_mask:0xf
    v_fma_f32 v242, -v233, v238, v242
    v_fmac_f32 v243, v233, v239
    v_cvt_pk_bf16_f32 v190, v240, v241
    v_mul_f32_dpp v234, v236, v242 row_newbcast:13 row_mask:0xf bank_mask:0xf
    v_mul_f32_dpp v237, v235, v242 row_newbcast:13 row_mask:0xf bank_mask:0xf
    v_cvt_pk_bf16_f32 v194, v242, -v243
    v_fmac_f32_dpp v234, -v235, v243 row_newbcast:13 row_mask:0xf bank_mask:0xf
    v_fmac_f32_dpp v237, v236, v243 row_newbcast:13 row_mask:0xf bank_mask:0xf
    v_cvt_pk_bf16_f32 v198, v234, -v237
    v_mul_f32_dpp v235, v153, v200 row_newbcast:3 row_mask:0xf bank_mask:0xf
    v_mul_f32_dpp v234, v152, v200 row_newbcast:3 row_mask:0xf bank_mask:0xf
    v_mul_f32_dpp v238, v153, v201 row_newbcast:3 row_mask:0xf bank_mask:0xf
    v_mul_f32_dpp v237, v152, v201 row_newbcast:3 row_mask:0xf bank_mask:0xf
    v_fract_f32 v235, v235
    v_exp_f32 v234, v234
    v_cos_f32 v236, v235
    v_sin_f32 v235, v235
    v_exp_f32 v237, v237
    v_mul_f32 v236, v234, v236
    v_cos_f32 v239, v238
    v_mul_f32 v235, v234, v235
    v_sin_f32 v238, v238
    v_mul_f32_dpp v232, v154, v237 row_newbcast:3 row_mask:0xf bank_mask:0xf
    v_mul_f32_dpp v233, v155, v237 row_newbcast:3 row_mask:0xf bank_mask:0xf
    v_cvt_pk_bf16_f32 v187, v236, v235
    v_mul_f32_dpp v240, v236, v236 row_newbcast:12 row_mask:0xf bank_mask:0xf
    v_mul_f32_dpp v241, v235, v236 row_newbcast:12 row_mask:0xf bank_mask:0xf
    v_mul_f32 v242, v232, v239
    v_mul_f32 v243, v232, v238
    v_fmac_f32_dpp v240, -v235, v235 row_newbcast:12 row_mask:0xf bank_mask:0xf
    v_fmac_f32_dpp v241, v236, v235 row_newbcast:12 row_mask:0xf bank_mask:0xf
    v_fma_f32 v242, -v233, v238, v242
    v_fmac_f32 v243, v233, v239
    v_cvt_pk_bf16_f32 v191, v240, v241
    v_mul_f32_dpp v234, v236, v242 row_newbcast:13 row_mask:0xf bank_mask:0xf
    v_mul_f32_dpp v237, v235, v242 row_newbcast:13 row_mask:0xf bank_mask:0xf
    v_cvt_pk_bf16_f32 v195, v242, -v243
    v_fmac_f32_dpp v234, -v235, v243 row_newbcast:13 row_mask:0xf bank_mask:0xf
    v_fmac_f32_dpp v237, v236, v243 row_newbcast:13 row_mask:0xf bank_mask:0xf
    v_cvt_pk_bf16_f32 v199, v234, -v237
    s_nop 1
    v_mfma_f32_16x16x32_bf16 v[136:139], v[184:187], v[192:195], 0
    v_mfma_f32_16x16x32_bf16 v[140:143], v[184:187], v[196:199], 0
    v_mfma_f32_16x16x32_bf16 v[144:147], v[188:191], v[192:195], 0
    v_mfma_f32_16x16x32_bf16 v[148:151], v[188:191], v[196:199], 0
    v_mul_f32_dpp v235, v153, v200 row_newbcast:4 row_mask:0xf bank_mask:0xf
    v_mul_f32_dpp v234, v152, v200 row_newbcast:4 row_mask:0xf bank_mask:0xf
    v_mul_f32_dpp v238, v153, v201 row_newbcast:4 row_mask:0xf bank_mask:0xf
    v_mul_f32_dpp v237, v152, v201 row_newbcast:4 row_mask:0xf bank_mask:0xf
    v_fract_f32 v235, v235
    v_exp_f32 v234, v234
    v_cos_f32 v236, v235
    v_sin_f32 v235, v235
    v_exp_f32 v237, v237
    v_mul_f32 v236, v234, v236
    v_cos_f32 v239, v238
    v_mul_f32 v235, v234, v235
    v_sin_f32 v238, v238
    v_mul_f32_dpp v232, v154, v237 row_newbcast:4 row_mask:0xf bank_mask:0xf
    v_mul_f32_dpp v233, v155, v237 row_newbcast:4 row_mask:0xf bank_mask:0xf
    v_cvt_pk_bf16_f32 v184, v236, v235
    v_mul_f32_dpp v240, v236, v236 row_newbcast:12 row_mask:0xf bank_mask:0xf
    v_mul_f32_dpp v241, v235, v236 row_newbcast:12 row_mask:0xf bank_mask:0xf
    v_mul_f32 v242, v232, v239
    v_mul_f32 v243, v232, v238
    v_fmac_f32_dpp v240, -v235, v235 row_newbcast:12 row_mask:0xf bank_mask:0xf
    v_fmac_f32_dpp v241, v236, v235 row_newbcast:12 row_mask:0xf bank_mask:0xf
    v_fma_f32 v242, -v233, v238, v242
    v_fmac_f32 v243, v233, v239
    v_cvt_pk_bf16_f32 v188, v240, v241
    v_mul_f32_dpp v234, v236, v242 row_newbcast:13 row_mask:0xf bank_mask:0xf
    v_mul_f32_dpp v237, v235, v242 row_newbcast:13 row_mask:0xf bank_mask:0xf
    v_cvt_pk_bf16_f32 v192, v242, -v243
    v_fmac_f32_dpp v234, -v235, v243 row_newbcast:13 row_mask:0xf bank_mask:0xf
    v_fmac_f32_dpp v237, v236, v243 row_newbcast:13 row_mask:0xf bank_mask:0xf
    v_cvt_pk_bf16_f32 v196, v234, -v237
    v_mul_f32_dpp v235, v153, v200 row_newbcast:5 row_mask:0xf bank_mask:0xf
    v_mul_f32_dpp v234, v152, v200 row_newbcast:5 row_mask:0xf bank_mask:0xf
    v_mul_f32_dpp v238, v153, v201 row_newbcast:5 row_mask:0xf bank_mask:0xf
    v_mul_f32_dpp v237, v152, v201 row_newbcast:5 row_mask:0xf bank_mask:0xf
    v_fract_f32 v235, v235
    v_exp_f32 v234, v234
    v_cos_f32 v236, v235
    v_sin_f32 v235, v235
    v_exp_f32 v237, v237
    v_mul_f32 v236, v234, v236
    v_cos_f32 v239, v238
    v_mul_f32 v235, v234, v235
    v_sin_f32 v238, v238
    v_mul_f32_dpp v232, v154, v237 row_newbcast:5 row_mask:0xf bank_mask:0xf
    v_mul_f32_dpp v233, v155, v237 row_newbcast:5 row_mask:0xf bank_mask:0xf
    v_cvt_pk_bf16_f32 v185, v236, v235
    v_mul_f32_dpp v240, v236, v236 row_newbcast:12 row_mask:0xf bank_mask:0xf
    v_mul_f32_dpp v241, v235, v236 row_newbcast:12 row_mask:0xf bank_mask:0xf
    v_mul_f32 v242, v232, v239
    v_mul_f32 v243, v232, v238
    v_fmac_f32_dpp v240, -v235, v235 row_newbcast:12 row_mask:0xf bank_mask:0xf
    v_fmac_f32_dpp v241, v236, v235 row_newbcast:12 row_mask:0xf bank_mask:0xf
    v_fma_f32 v242, -v233, v238, v242
    v_fmac_f32 v243, v233, v239
    v_cvt_pk_bf16_f32 v189, v240, v241
    v_mul_f32_dpp v234, v236, v242 row_newbcast:13 row_mask:0xf bank_mask:0xf
    v_mul_f32_dpp v237, v235, v242 row_newbcast:13 row_mask:0xf bank_mask:0xf
    v_cvt_pk_bf16_f32 v193, v242, -v243
    v_fmac_f32_dpp v234, -v235, v243 row_newbcast:13 row_mask:0xf bank_mask:0xf
    v_fmac_f32_dpp v237, v236, v243 row_newbcast:13 row_mask:0xf bank_mask:0xf
    v_cvt_pk_bf16_f32 v197, v234, -v237
    v_mul_f32_dpp v235, v153, v200 row_newbcast:6 row_mask:0xf bank_mask:0xf
    v_mul_f32_dpp v234, v152, v200 row_newbcast:6 row_mask:0xf bank_mask:0xf
    v_mul_f32_dpp v238, v153, v201 row_newbcast:6 row_mask:0xf bank_mask:0xf
    v_mul_f32_dpp v237, v152, v201 row_newbcast:6 row_mask:0xf bank_mask:0xf
    v_fract_f32 v235, v235
    v_exp_f32 v234, v234
    v_cos_f32 v236, v235
    v_sin_f32 v235, v235
    v_exp_f32 v237, v237
    v_mul_f32 v236, v234, v236
    v_cos_f32 v239, v238
    v_mul_f32 v235, v234, v235
    v_sin_f32 v238, v238
    v_mul_f32_dpp v232, v154, v237 row_newbcast:6 row_mask:0xf bank_mask:0xf
    v_mul_f32_dpp v233, v155, v237 row_newbcast:6 row_mask:0xf bank_mask:0xf
    v_cvt_pk_bf16_f32 v186, v236, v235
    v_mul_f32_dpp v240, v236, v236 row_newbcast:12 row_mask:0xf bank_mask:0xf
    v_mul_f32_dpp v241, v235, v236 row_newbcast:12 row_mask:0xf bank_mask:0xf
    v_mul_f32 v242, v232, v239
    v_mul_f32 v243, v232, v238
    v_fmac_f32_dpp v240, -v235, v235 row_newbcast:12 row_mask:0xf bank_mask:0xf
    v_fmac_f32_dpp v241, v236, v235 row_newbcast:12 row_mask:0xf bank_mask:0xf
    v_fma_f32 v242, -v233, v238, v242
    v_fmac_f32 v243, v233, v239
    v_cvt_pk_bf16_f32 v190, v240, v241
    v_mul_f32_dpp v234, v236, v242 row_newbcast:13 row_mask:0xf bank_mask:0xf
    v_mul_f32_dpp v237, v235, v242 row_newbcast:13 row_mask:0xf bank_mask:0xf
    v_cvt_pk_bf16_f32 v194, v242, -v243
    v_fmac_f32_dpp v234, -v235, v243 row_newbcast:13 row_mask:0xf bank_mask:0xf
    v_fmac_f32_dpp v237, v236, v243 row_newbcast:13 row_mask:0xf bank_mask:0xf
    v_cvt_pk_bf16_f32 v198, v234, -v237
    v_mul_f32_dpp v235, v153, v200 row_newbcast:7 row_mask:0xf bank_mask:0xf
    v_mul_f32_dpp v234, v152, v200 row_newbcast:7 row_mask:0xf bank_mask:0xf
    v_mul_f32_dpp v238, v153, v201 row_newbcast:7 row_mask:0xf bank_mask:0xf
    v_mul_f32_dpp v237, v152, v201 row_newbcast:7 row_mask:0xf bank_mask:0xf
    v_fract_f32 v235, v235
    v_exp_f32 v234, v234
    v_cos_f32 v236, v235
    v_sin_f32 v235, v235
    v_exp_f32 v237, v237
    v_mul_f32 v236, v234, v236
    v_cos_f32 v239, v238
    v_mul_f32 v235, v234, v235
    v_sin_f32 v238, v238
    v_mul_f32_dpp v232, v154, v237 row_newbcast:7 row_mask:0xf bank_mask:0xf
    v_mul_f32_dpp v233, v155, v237 row_newbcast:7 row_mask:0xf bank_mask:0xf
    v_cvt_pk_bf16_f32 v187, v236, v235
    v_mul_f32_dpp v240, v236, v236 row_newbcast:12 row_mask:0xf bank_mask:0xf
    v_mul_f32_dpp v241, v235, v236 row_newbcast:12 row_mask:0xf bank_mask:0xf
    v_mul_f32 v242, v232, v239
    v_mul_f32 v243, v232, v238
    v_fmac_f32_dpp v240, -v235, v235 row_newbcast:12 row_mask:0xf bank_mask:0xf
    v_fmac_f32_dpp v241, v236, v235 row_newbcast:12 row_mask:0xf bank_mask:0xf
    v_fma_f32 v242, -v233, v238, v242
    v_fmac_f32 v243, v233, v239
    v_cvt_pk_bf16_f32 v191, v240, v241
    v_mul_f32_dpp v234, v236, v242 row_newbcast:13 row_mask:0xf bank_mask:0xf
    v_mul_f32_dpp v237, v235, v242 row_newbcast:13 row_mask:0xf bank_mask:0xf
    v_cvt_pk_bf16_f32 v195, v242, -v243
    v_fmac_f32_dpp v234, -v235, v243 row_newbcast:13 row_mask:0xf bank_mask:0xf
    v_fmac_f32_dpp v237, v236, v243 row_newbcast:13 row_mask:0xf bank_mask:0xf
    v_cvt_pk_bf16_f32 v199, v234, -v237
    s_nop 1
    v_mfma_f32_16x16x32_bf16 v[136:139], v[184:187], v[192:195], v[136:139]
    v_mfma_f32_16x16x32_bf16 v[140:143], v[184:187], v[196:199], v[140:143]
    v_mfma_f32_16x16x32_bf16 v[144:147], v[188:191], v[192:195], v[144:147]
    v_mfma_f32_16x16x32_bf16 v[148:151], v[188:191], v[196:199], v[148:151]
    v_mul_f32_dpp v235, v153, v200 row_newbcast:8 row_mask:0xf bank_mask:0xf
    v_mul_f32_dpp v234, v152, v200 row_newbcast:8 row_mask:0xf bank_mask:0xf
    v_mul_f32_dpp v238, v153, v201 row_newbcast:8 row_mask:0xf bank_mask:0xf
    v_mul_f32_dpp v237, v152, v201 row_newbcast:8 row_mask:0xf bank_mask:0xf
    v_fract_f32 v235, v235
    v_exp_f32 v234, v234
    v_cos_f32 v236, v235
    v_sin_f32 v235, v235
    v_exp_f32 v237, v237
    v_mul_f32 v236, v234, v236
    v_cos_f32 v239, v238
    v_mul_f32 v235, v234, v235
    v_sin_f32 v238, v238
    v_mul_f32_dpp v232, v154, v237 row_newbcast:8 row_mask:0xf bank_mask:0xf
    v_mul_f32_dpp v233, v155, v237 row_newbcast:8 row_mask:0xf bank_mask:0xf
    v_cvt_pk_bf16_f32 v184, v236, v235
    v_mul_f32_dpp v240, v236, v236 row_newbcast:12 row_mask:0xf bank_mask:0xf
    v_mul_f32_dpp v241, v235, v236 row_newbcast:12 row_mask:0xf bank_mask:0xf
    v_mul_f32 v242, v232, v239
    v_mul_f32 v243, v232, v238
    v_fmac_f32_dpp v240, -v235, v235 row_newbcast:12 row_mask:0xf bank_mask:0xf
    v_fmac_f32_dpp v241, v236, v235 row_newbcast:12 row_mask:0xf bank_mask:0xf
    v_fma_f32 v242, -v233, v238, v242
    v_fmac_f32 v243, v233, v239
    v_cvt_pk_bf16_f32 v188, v240, v241
    v_mul_f32_dpp v234, v236, v242 row_newbcast:13 row_mask:0xf bank_mask:0xf
    v_mul_f32_dpp v237, v235, v242 row_newbcast:13 row_mask:0xf bank_mask:0xf
    v_cvt_pk_bf16_f32 v192, v242, -v243
    v_fmac_f32_dpp v234, -v235, v243 row_newbcast:13 row_mask:0xf bank_mask:0xf
    v_fmac_f32_dpp v237, v236, v243 row_newbcast:13 row_mask:0xf bank_mask:0xf
    v_cvt_pk_bf16_f32 v196, v234, -v237
    v_mul_f32_dpp v235, v153, v200 row_newbcast:9 row_mask:0xf bank_mask:0xf
    v_mul_f32_dpp v234, v152, v200 row_newbcast:9 row_mask:0xf bank_mask:0xf
    v_mul_f32_dpp v238, v153, v201 row_newbcast:9 row_mask:0xf bank_mask:0xf
    v_mul_f32_dpp v237, v152, v201 row_newbcast:9 row_mask:0xf bank_mask:0xf
    v_fract_f32 v235, v235
    v_exp_f32 v234, v234
    v_cos_f32 v236, v235
    v_sin_f32 v235, v235
    v_exp_f32 v237, v237
    v_mul_f32 v236, v234, v236
    v_cos_f32 v239, v238
    v_mul_f32 v235, v234, v235
    v_sin_f32 v238, v238
    v_mul_f32_dpp v232, v154, v237 row_newbcast:9 row_mask:0xf bank_mask:0xf
    v_mul_f32_dpp v233, v155, v237 row_newbcast:9 row_mask:0xf bank_mask:0xf
    v_cvt_pk_bf16_f32 v185, v236, v235
    v_mul_f32_dpp v240, v236, v236 row_newbcast:12 row_mask:0xf bank_mask:0xf
    v_mul_f32_dpp v241, v235, v236 row_newbcast:12 row_mask:0xf bank_mask:0xf
    v_mul_f32 v242, v232, v239
    v_mul_f32 v243, v232, v238
    v_fmac_f32_dpp v240, -v235, v235 row_newbcast:12 row_mask:0xf bank_mask:0xf
    v_fmac_f32_dpp v241, v236, v235 row_newbcast:12 row_mask:0xf bank_mask:0xf
    v_fma_f32 v242, -v233, v238, v242
    v_fmac_f32 v243, v233, v239
    v_cvt_pk_bf16_f32 v189, v240, v241
    v_mul_f32_dpp v234, v236, v242 row_newbcast:13 row_mask:0xf bank_mask:0xf
    v_mul_f32_dpp v237, v235, v242 row_newbcast:13 row_mask:0xf bank_mask:0xf
    v_cvt_pk_bf16_f32 v193, v242, -v243
    v_fmac_f32_dpp v234, -v235, v243 row_newbcast:13 row_mask:0xf bank_mask:0xf
    v_fmac_f32_dpp v237, v236, v243 row_newbcast:13 row_mask:0xf bank_mask:0xf
    v_cvt_pk_bf16_f32 v197, v234, -v237
    v_mul_f32_dpp v235, v153, v200 row_newbcast:10 row_mask:0xf bank_mask:0xf
    v_mul_f32_dpp v234, v152, v200 row_newbcast:10 row_mask:0xf bank_mask:0xf
    v_mul_f32_dpp v238, v153, v201 row_newbcast:10 row_mask:0xf bank_mask:0xf
    v_mul_f32_dpp v237, v152, v201 row_newbcast:10 row_mask:0xf bank_mask:0xf
    v_fract_f32 v235, v235
    v_exp_f32 v234, v234
    v_cos_f32 v236, v235
    v_sin_f32 v235, v235
    v_exp_f32 v237, v237
    v_mul_f32 v236, v234, v236
    v_cos_f32 v239, v238
    v_mul_f32 v235, v234, v235
    v_sin_f32 v238, v238
    v_mul_f32_dpp v232, v154, v237 row_newbcast:10 row_mask:0xf bank_mask:0xf
    v_mul_f32_dpp v233, v155, v237 row_newbcast:10 row_mask:0xf bank_mask:0xf
    v_cvt_pk_bf16_f32 v186, v236, v235
    v_mul_f32_dpp v240, v236, v236 row_newbcast:12 row_mask:0xf bank_mask:0xf
    v_mul_f32_dpp v241, v235, v236 row_newbcast:12 row_mask:0xf bank_mask:0xf
    v_mul_f32 v242, v232, v239
    v_mul_f32 v243, v232, v238
    v_fmac_f32_dpp v240, -v235, v235 row_newbcast:12 row_mask:0xf bank_mask:0xf
    v_fmac_f32_dpp v241, v236, v235 row_newbcast:12 row_mask:0xf bank_mask:0xf
    v_fma_f32 v242, -v233, v238, v242
    v_fmac_f32 v243, v233, v239
    v_cvt_pk_bf16_f32 v190, v240, v241
    v_mul_f32_dpp v234, v236, v242 row_newbcast:13 row_mask:0xf bank_mask:0xf
    v_mul_f32_dpp v237, v235, v242 row_newbcast:13 row_mask:0xf bank_mask:0xf
    v_cvt_pk_bf16_f32 v194, v242, -v243
    v_fmac_f32_dpp v234, -v235, v243 row_newbcast:13 row_mask:0xf bank_mask:0xf
    v_fmac_f32_dpp v237, v236, v243 row_newbcast:13 row_mask:0xf bank_mask:0xf
    v_cvt_pk_bf16_f32 v198, v234, -v237
    v_mul_f32_dpp v235, v153, v200 row_newbcast:11 row_mask:0xf bank_mask:0xf
    v_mul_f32_dpp v234, v152, v200 row_newbcast:11 row_mask:0xf bank_mask:0xf
    v_mul_f32_dpp v238, v153, v201 row_newbcast:11 row_mask:0xf bank_mask:0xf
    v_mul_f32_dpp v237, v152, v201 row_newbcast:11 row_mask:0xf bank_mask:0xf
    v_fract_f32 v235, v235
    v_exp_f32 v234, v234
    v_cos_f32 v236, v235
    v_sin_f32 v235, v235
    v_exp_f32 v237, v237
    v_mul_f32 v236, v234, v236
    v_cos_f32 v239, v238
    v_mul_f32 v235, v234, v235
    v_sin_f32 v238, v238
    v_mul_f32_dpp v232, v154, v237 row_newbcast:11 row_mask:0xf bank_mask:0xf
    v_mul_f32_dpp v233, v155, v237 row_newbcast:11 row_mask:0xf bank_mask:0xf
    v_cvt_pk_bf16_f32 v187, v236, v235
    v_mul_f32_dpp v240, v236, v236 row_newbcast:12 row_mask:0xf bank_mask:0xf
    v_mul_f32_dpp v241, v235, v236 row_newbcast:12 row_mask:0xf bank_mask:0xf
    v_mul_f32 v242, v232, v239
    v_mul_f32 v243, v232, v238
    v_fmac_f32_dpp v240, -v235, v235 row_newbcast:12 row_mask:0xf bank_mask:0xf
    v_fmac_f32_dpp v241, v236, v235 row_newbcast:12 row_mask:0xf bank_mask:0xf
    v_fma_f32 v242, -v233, v238, v242
    v_fmac_f32 v243, v233, v239
    v_cvt_pk_bf16_f32 v191, v240, v241
    v_mul_f32_dpp v234, v236, v242 row_newbcast:13 row_mask:0xf bank_mask:0xf
    v_mul_f32_dpp v237, v235, v242 row_newbcast:13 row_mask:0xf bank_mask:0xf
    v_cvt_pk_bf16_f32 v195, v242, -v243
    v_fmac_f32_dpp v234, -v235, v243 row_newbcast:13 row_mask:0xf bank_mask:0xf
    v_fmac_f32_dpp v237, v236, v243 row_newbcast:13 row_mask:0xf bank_mask:0xf
    v_cvt_pk_bf16_f32 v199, v234, -v237
    s_nop 1
    v_mfma_f32_16x16x32_bf16 v[136:139], v[184:187], v[192:195], v[136:139]
    v_mfma_f32_16x16x32_bf16 v[140:143], v[184:187], v[196:199], v[140:143]
    v_mfma_f32_16x16x32_bf16 v[144:147], v[188:191], v[192:195], v[144:147]
    v_mfma_f32_16x16x32_bf16 v[148:151], v[188:191], v[196:199], v[148:151]
    v_mul_f32_dpp v235, v153, v200 row_newbcast:12 row_mask:0xf bank_mask:0xf
    v_mul_f32_dpp v234, v152, v200 row_newbcast:12 row_mask:0xf bank_mask:0xf
    v_mul_f32_dpp v238, v153, v201 row_newbcast:12 row_mask:0xf bank_mask:0xf
    v_mul_f32_dpp v237, v152, v201 row_newbcast:12 row_mask:0xf bank_mask:0xf
    v_fract_f32 v235, v235
    v_exp_f32 v234, v234
    v_cos_f32 v236, v235
    v_sin_f32 v235, v235
    v_exp_f32 v237, v237
    v_mul_f32 v236, v234, v236
    v_cos_f32 v239, v238
    v_mul_f32 v235, v234, v235
    v_sin_f32 v238, v238
    v_mul_f32_dpp v232, v154, v237 row_newbcast:12 row_mask:0xf bank_mask:0xf
    v_mul_f32_dpp v233, v155, v237 row_newbcast:12 row_mask:0xf bank_mask:0xf
    v_cvt_pk_bf16_f32 v184, v236, v235
    v_mul_f32_dpp v240, v236, v236 row_newbcast:12 row_mask:0xf bank_mask:0xf
    v_mul_f32_dpp v241, v235, v236 row_newbcast:12 row_mask:0xf bank_mask:0xf
    v_mul_f32 v242, v232, v239
    v_mul_f32 v243, v232, v238
    v_fmac_f32_dpp v240, -v235, v235 row_newbcast:12 row_mask:0xf bank_mask:0xf
    v_fmac_f32_dpp v241, v236, v235 row_newbcast:12 row_mask:0xf bank_mask:0xf
    v_fma_f32 v242, -v233, v238, v242
    v_fmac_f32 v243, v233, v239
    v_cvt_pk_bf16_f32 v188, v240, v241
    v_mul_f32_dpp v234, v236, v242 row_newbcast:13 row_mask:0xf bank_mask:0xf
    v_mul_f32_dpp v237, v235, v242 row_newbcast:13 row_mask:0xf bank_mask:0xf
    v_cvt_pk_bf16_f32 v192, v242, -v243
    v_fmac_f32_dpp v234, -v235, v243 row_newbcast:13 row_mask:0xf bank_mask:0xf
    v_fmac_f32_dpp v237, v236, v243 row_newbcast:13 row_mask:0xf bank_mask:0xf
    v_cvt_pk_bf16_f32 v196, v234, -v237
    v_mul_f32_dpp v235, v153, v200 row_newbcast:13 row_mask:0xf bank_mask:0xf
    v_mul_f32_dpp v234, v152, v200 row_newbcast:13 row_mask:0xf bank_mask:0xf
    v_mul_f32_dpp v238, v153, v201 row_newbcast:13 row_mask:0xf bank_mask:0xf
    v_mul_f32_dpp v237, v152, v201 row_newbcast:13 row_mask:0xf bank_mask:0xf
    v_fract_f32 v235, v235
    v_exp_f32 v234, v234
    v_cos_f32 v236, v235
    v_sin_f32 v235, v235
    v_exp_f32 v237, v237
    v_mul_f32 v236, v234, v236
    v_cos_f32 v239, v238
    v_mul_f32 v235, v234, v235
    v_sin_f32 v238, v238
    v_mul_f32_dpp v232, v154, v237 row_newbcast:13 row_mask:0xf bank_mask:0xf
    v_mul_f32_dpp v233, v155, v237 row_newbcast:13 row_mask:0xf bank_mask:0xf
    v_cvt_pk_bf16_f32 v185, v236, v235
    v_mul_f32_dpp v240, v236, v236 row_newbcast:12 row_mask:0xf bank_mask:0xf
    v_mul_f32_dpp v241, v235, v236 row_newbcast:12 row_mask:0xf bank_mask:0xf
    v_mul_f32 v242, v232, v239
    v_mul_f32 v243, v232, v238
    v_fmac_f32_dpp v240, -v235, v235 row_newbcast:12 row_mask:0xf bank_mask:0xf
    v_fmac_f32_dpp v241, v236, v235 row_newbcast:12 row_mask:0xf bank_mask:0xf
    v_fma_f32 v242, -v233, v238, v242
    v_fmac_f32 v243, v233, v239
    v_cvt_pk_bf16_f32 v189, v240, v241
    v_mul_f32_dpp v234, v236, v242 row_newbcast:13 row_mask:0xf bank_mask:0xf
    v_mul_f32_dpp v237, v235, v242 row_newbcast:13 row_mask:0xf bank_mask:0xf
    v_cvt_pk_bf16_f32 v193, v242, -v243
    v_fmac_f32_dpp v234, -v235, v243 row_newbcast:13 row_mask:0xf bank_mask:0xf
    v_fmac_f32_dpp v237, v236, v243 row_newbcast:13 row_mask:0xf bank_mask:0xf
    v_cvt_pk_bf16_f32 v197, v234, -v237
    v_mul_f32_dpp v235, v153, v200 row_newbcast:14 row_mask:0xf bank_mask:0xf
    v_mul_f32_dpp v234, v152, v200 row_newbcast:14 row_mask:0xf bank_mask:0xf
    v_mul_f32_dpp v238, v153, v201 row_newbcast:14 row_mask:0xf bank_mask:0xf
    v_mul_f32_dpp v237, v152, v201 row_newbcast:14 row_mask:0xf bank_mask:0xf
    v_fract_f32 v235, v235
    v_exp_f32 v234, v234
    v_cos_f32 v236, v235
    v_sin_f32 v235, v235
    v_exp_f32 v237, v237
    v_mul_f32 v236, v234, v236
    v_cos_f32 v239, v238
    v_mul_f32 v235, v234, v235
    v_sin_f32 v238, v238
    v_mul_f32_dpp v232, v154, v237 row_newbcast:14 row_mask:0xf bank_mask:0xf
    v_mul_f32_dpp v233, v155, v237 row_newbcast:14 row_mask:0xf bank_mask:0xf
    v_cvt_pk_bf16_f32 v186, v236, v235
    v_mul_f32_dpp v240, v236, v236 row_newbcast:12 row_mask:0xf bank_mask:0xf
    v_mul_f32_dpp v241, v235, v236 row_newbcast:12 row_mask:0xf bank_mask:0xf
    v_mul_f32 v242, v232, v239
    v_mul_f32 v243, v232, v238
    v_fmac_f32_dpp v240, -v235, v235 row_newbcast:12 row_mask:0xf bank_mask:0xf
    v_fmac_f32_dpp v241, v236, v235 row_newbcast:12 row_mask:0xf bank_mask:0xf
    v_fma_f32 v242, -v233, v238, v242
    v_fmac_f32 v243, v233, v239
    v_cvt_pk_bf16_f32 v190, v240, v241
    v_mul_f32_dpp v234, v236, v242 row_newbcast:13 row_mask:0xf bank_mask:0xf
    v_mul_f32_dpp v237, v235, v242 row_newbcast:13 row_mask:0xf bank_mask:0xf
    v_cvt_pk_bf16_f32 v194, v242, -v243
    v_fmac_f32_dpp v234, -v235, v243 row_newbcast:13 row_mask:0xf bank_mask:0xf
    v_fmac_f32_dpp v237, v236, v243 row_newbcast:13 row_mask:0xf bank_mask:0xf
    v_cvt_pk_bf16_f32 v198, v234, -v237
    v_mul_f32_dpp v235, v153, v200 row_newbcast:15 row_mask:0xf bank_mask:0xf
    v_mul_f32_dpp v234, v152, v200 row_newbcast:15 row_mask:0xf bank_mask:0xf
    v_mul_f32_dpp v238, v153, v201 row_newbcast:15 row_mask:0xf bank_mask:0xf
    v_mul_f32_dpp v237, v152, v201 row_newbcast:15 row_mask:0xf bank_mask:0xf
    v_fract_f32 v235, v235
    v_exp_f32 v234, v234
    v_cos_f32 v236, v235
    v_sin_f32 v235, v235
    v_exp_f32 v237, v237
    v_mul_f32 v236, v234, v236
    v_cos_f32 v239, v238
    v_mul_f32 v235, v234, v235
    v_sin_f32 v238, v238
    v_mul_f32_dpp v232, v154, v237 row_newbcast:15 row_mask:0xf bank_mask:0xf
    v_mul_f32_dpp v233, v155, v237 row_newbcast:15 row_mask:0xf bank_mask:0xf
    v_cvt_pk_bf16_f32 v187, v236, v235
    v_mul_f32_dpp v240, v236, v236 row_newbcast:12 row_mask:0xf bank_mask:0xf
    v_mul_f32_dpp v241, v235, v236 row_newbcast:12 row_mask:0xf bank_mask:0xf
    v_mul_f32 v242, v232, v239
    v_mul_f32 v243, v232, v238
    v_fmac_f32_dpp v240, -v235, v235 row_newbcast:12 row_mask:0xf bank_mask:0xf
    v_fmac_f32_dpp v241, v236, v235 row_newbcast:12 row_mask:0xf bank_mask:0xf
    v_fma_f32 v242, -v233, v238, v242
    v_fmac_f32 v243, v233, v239
    v_cvt_pk_bf16_f32 v191, v240, v241
    v_mul_f32_dpp v234, v236, v242 row_newbcast:13 row_mask:0xf bank_mask:0xf
    v_mul_f32_dpp v237, v235, v242 row_newbcast:13 row_mask:0xf bank_mask:0xf
    v_cvt_pk_bf16_f32 v195, v242, -v243
    v_fmac_f32_dpp v234, -v235, v243 row_newbcast:13 row_mask:0xf bank_mask:0xf
    v_fmac_f32_dpp v237, v236, v243 row_newbcast:13 row_mask:0xf bank_mask:0xf
    v_cvt_pk_bf16_f32 v199, v234, -v237
    s_nop 1
    v_mfma_f32_16x16x32_bf16 v[136:139], v[184:187], v[192:195], v[136:139]
    v_mfma_f32_16x16x32_bf16 v[140:143], v[184:187], v[196:199], v[140:143]
    v_mfma_f32_16x16x32_bf16 v[144:147], v[188:191], v[192:195], v[144:147]
    v_mfma_f32_16x16x32_bf16 v[148:151], v[188:191], v[196:199], v[148:151]
    v_mul_f32_dpp v235, v157, v200 row_newbcast:0 row_mask:0xf bank_mask:0xf
    v_mul_f32_dpp v234, v156, v200 row_newbcast:0 row_mask:0xf bank_mask:0xf
    v_mul_f32_dpp v238, v157, v201 row_newbcast:0 row_mask:0xf bank_mask:0xf
    v_mul_f32_dpp v237, v156, v201 row_newbcast:0 row_mask:0xf bank_mask:0xf
    v_fract_f32 v235, v235
    v_exp_f32 v234, v234
    v_cos_f32 v236, v235
    v_sin_f32 v235, v235
    v_exp_f32 v237, v237
    v_mul_f32 v236, v234, v236
    v_cos_f32 v239, v238
    v_mul_f32 v235, v234, v235
    v_sin_f32 v238, v238
    v_mul_f32_dpp v232, v158, v237 row_newbcast:0 row_mask:0xf bank_mask:0xf
    v_mul_f32_dpp v233, v159, v237 row_newbcast:0 row_mask:0xf bank_mask:0xf
    v_cvt_pk_bf16_f32 v184, v236, v235
    v_mul_f32_dpp v240, v236, v236 row_newbcast:12 row_mask:0xf bank_mask:0xf
    v_mul_f32_dpp v241, v235, v236 row_newbcast:12 row_mask:0xf bank_mask:0xf
    v_mul_f32 v242, v232, v239
    v_mul_f32 v243, v232, v238
    v_fmac_f32_dpp v240, -v235, v235 row_newbcast:12 row_mask:0xf bank_mask:0xf
    v_fmac_f32_dpp v241, v236, v235 row_newbcast:12 row_mask:0xf bank_mask:0xf
    v_fma_f32 v242, -v233, v238, v242
    v_fmac_f32 v243, v233, v239
    v_cvt_pk_bf16_f32 v188, v240, v241
    v_mul_f32_dpp v234, v236, v242 row_newbcast:13 row_mask:0xf bank_mask:0xf
    v_mul_f32_dpp v237, v235, v242 row_newbcast:13 row_mask:0xf bank_mask:0xf
    v_cvt_pk_bf16_f32 v192, v242, -v243
    v_fmac_f32_dpp v234, -v235, v243 row_newbcast:13 row_mask:0xf bank_mask:0xf
    v_fmac_f32_dpp v237, v236, v243 row_newbcast:13 row_mask:0xf bank_mask:0xf
    v_cvt_pk_bf16_f32 v196, v234, -v237
    v_mul_f32_dpp v235, v157, v200 row_newbcast:1 row_mask:0xf bank_mask:0xf
    v_mul_f32_dpp v234, v156, v200 row_newbcast:1 row_mask:0xf bank_mask:0xf
    v_mul_f32_dpp v238, v157, v201 row_newbcast:1 row_mask:0xf bank_mask:0xf
    v_mul_f32_dpp v237, v156, v201 row_newbcast:1 row_mask:0xf bank_mask:0xf
    v_fract_f32 v235, v235
    v_exp_f32 v234, v234
    v_cos_f32 v236, v235
    v_sin_f32 v235, v235
    v_exp_f32 v237, v237
    v_mul_f32 v236, v234, v236
    v_cos_f32 v239, v238
    v_mul_f32 v235, v234, v235
    v_sin_f32 v238, v238
    v_mul_f32_dpp v232, v158, v237 row_newbcast:1 row_mask:0xf bank_mask:0xf
    v_mul_f32_dpp v233, v159, v237 row_newbcast:1 row_mask:0xf bank_mask:0xf
    v_cvt_pk_bf16_f32 v185, v236, v235
    v_mul_f32_dpp v240, v236, v236 row_newbcast:12 row_mask:0xf bank_mask:0xf
    v_mul_f32_dpp v241, v235, v236 row_newbcast:12 row_mask:0xf bank_mask:0xf
    v_mul_f32 v242, v232, v239
    v_mul_f32 v243, v232, v238
    v_fmac_f32_dpp v240, -v235, v235 row_newbcast:12 row_mask:0xf bank_mask:0xf
    v_fmac_f32_dpp v241, v236, v235 row_newbcast:12 row_mask:0xf bank_mask:0xf
    v_fma_f32 v242, -v233, v238, v242
    v_fmac_f32 v243, v233, v239
    v_cvt_pk_bf16_f32 v189, v240, v241
    v_mul_f32_dpp v234, v236, v242 row_newbcast:13 row_mask:0xf bank_mask:0xf
    v_mul_f32_dpp v237, v235, v242 row_newbcast:13 row_mask:0xf bank_mask:0xf
    v_cvt_pk_bf16_f32 v193, v242, -v243
    v_fmac_f32_dpp v234, -v235, v243 row_newbcast:13 row_mask:0xf bank_mask:0xf
    v_fmac_f32_dpp v237, v236, v243 row_newbcast:13 row_mask:0xf bank_mask:0xf
    v_cvt_pk_bf16_f32 v197, v234, -v237
    v_mul_f32_dpp v235, v157, v200 row_newbcast:2 row_mask:0xf bank_mask:0xf
    v_mul_f32_dpp v234, v156, v200 row_newbcast:2 row_mask:0xf bank_mask:0xf
    v_mul_f32_dpp v238, v157, v201 row_newbcast:2 row_mask:0xf bank_mask:0xf
    v_mul_f32_dpp v237, v156, v201 row_newbcast:2 row_mask:0xf bank_mask:0xf
    v_fract_f32 v235, v235
    v_exp_f32 v234, v234
    v_cos_f32 v236, v235
    v_sin_f32 v235, v235
    v_exp_f32 v237, v237
    v_mul_f32 v236, v234, v236
    v_cos_f32 v239, v238
    v_mul_f32 v235, v234, v235
    v_sin_f32 v238, v238
    v_mul_f32_dpp v232, v158, v237 row_newbcast:2 row_mask:0xf bank_mask:0xf
    v_mul_f32_dpp v233, v159, v237 row_newbcast:2 row_mask:0xf bank_mask:0xf
    v_cvt_pk_bf16_f32 v186, v236, v235
    v_mul_f32_dpp v240, v236, v236 row_newbcast:12 row_mask:0xf bank_mask:0xf
    v_mul_f32_dpp v241, v235, v236 row_newbcast:12 row_mask:0xf bank_mask:0xf
    v_mul_f32 v242, v232, v239
    v_mul_f32 v243, v232, v238
    v_fmac_f32_dpp v240, -v235, v235 row_newbcast:12 row_mask:0xf bank_mask:0xf
    v_fmac_f32_dpp v241, v236, v235 row_newbcast:12 row_mask:0xf bank_mask:0xf
    v_fma_f32 v242, -v233, v238, v242
    v_fmac_f32 v243, v233, v239
    v_cvt_pk_bf16_f32 v190, v240, v241
    v_mul_f32_dpp v234, v236, v242 row_newbcast:13 row_mask:0xf bank_mask:0xf
    v_mul_f32_dpp v237, v235, v242 row_newbcast:13 row_mask:0xf bank_mask:0xf
    v_cvt_pk_bf16_f32 v194, v242, -v243
    v_fmac_f32_dpp v234, -v235, v243 row_newbcast:13 row_mask:0xf bank_mask:0xf
    v_fmac_f32_dpp v237, v236, v243 row_newbcast:13 row_mask:0xf bank_mask:0xf
    v_cvt_pk_bf16_f32 v198, v234, -v237
    v_mul_f32_dpp v235, v157, v200 row_newbcast:3 row_mask:0xf bank_mask:0xf
    v_mul_f32_dpp v234, v156, v200 row_newbcast:3 row_mask:0xf bank_mask:0xf
    v_mul_f32_dpp v238, v157, v201 row_newbcast:3 row_mask:0xf bank_mask:0xf
    v_mul_f32_dpp v237, v156, v201 row_newbcast:3 row_mask:0xf bank_mask:0xf
    v_fract_f32 v235, v235
    v_exp_f32 v234, v234
    v_cos_f32 v236, v235
    v_sin_f32 v235, v235
    v_exp_f32 v237, v237
    v_mul_f32 v236, v234, v236
    v_cos_f32 v239, v238
    v_mul_f32 v235, v234, v235
    v_sin_f32 v238, v238
    v_mul_f32_dpp v232, v158, v237 row_newbcast:3 row_mask:0xf bank_mask:0xf
    v_mul_f32_dpp v233, v159, v237 row_newbcast:3 row_mask:0xf bank_mask:0xf
    v_cvt_pk_bf16_f32 v187, v236, v235
    v_mul_f32_dpp v240, v236, v236 row_newbcast:12 row_mask:0xf bank_mask:0xf
    v_mul_f32_dpp v241, v235, v236 row_newbcast:12 row_mask:0xf bank_mask:0xf
    v_mul_f32 v242, v232, v239
    v_mul_f32 v243, v232, v238
    v_fmac_f32_dpp v240, -v235, v235 row_newbcast:12 row_mask:0xf bank_mask:0xf
    v_fmac_f32_dpp v241, v236, v235 row_newbcast:12 row_mask:0xf bank_mask:0xf
    v_fma_f32 v242, -v233, v238, v242
    v_fmac_f32 v243, v233, v239
    v_cvt_pk_bf16_f32 v191, v240, v241
    v_mul_f32_dpp v234, v236, v242 row_newbcast:13 row_mask:0xf bank_mask:0xf
    v_mul_f32_dpp v237, v235, v242 row_newbcast:13 row_mask:0xf bank_mask:0xf
    v_cvt_pk_bf16_f32 v195, v242, -v243
    v_fmac_f32_dpp v234, -v235, v243 row_newbcast:13 row_mask:0xf bank_mask:0xf
    v_fmac_f32_dpp v237, v236, v243 row_newbcast:13 row_mask:0xf bank_mask:0xf
    v_cvt_pk_bf16_f32 v199, v234, -v237
    s_nop 1
    v_mfma_f32_16x16x32_bf16 v[136:139], v[184:187], v[192:195], v[136:139]
    v_mfma_f32_16x16x32_bf16 v[140:143], v[184:187], v[196:199], v[140:143]
    v_mfma_f32_16x16x32_bf16 v[144:147], v[188:191], v[192:195], v[144:147]
    v_mfma_f32_16x16x32_bf16 v[148:151], v[188:191], v[196:199], v[148:151]
    v_mul_f32_dpp v235, v157, v200 row_newbcast:4 row_mask:0xf bank_mask:0xf
    v_mul_f32_dpp v234, v156, v200 row_newbcast:4 row_mask:0xf bank_mask:0xf
    v_mul_f32_dpp v238, v157, v201 row_newbcast:4 row_mask:0xf bank_mask:0xf
    v_mul_f32_dpp v237, v156, v201 row_newbcast:4 row_mask:0xf bank_mask:0xf
    v_fract_f32 v235, v235
    v_exp_f32 v234, v234
    v_cos_f32 v236, v235
    v_sin_f32 v235, v235
    v_exp_f32 v237, v237
    v_mul_f32 v236, v234, v236
    v_cos_f32 v239, v238
    v_mul_f32 v235, v234, v235
    v_sin_f32 v238, v238
    v_mul_f32_dpp v232, v158, v237 row_newbcast:4 row_mask:0xf bank_mask:0xf
    v_mul_f32_dpp v233, v159, v237 row_newbcast:4 row_mask:0xf bank_mask:0xf
    v_cvt_pk_bf16_f32 v184, v236, v235
    v_mul_f32_dpp v240, v236, v236 row_newbcast:12 row_mask:0xf bank_mask:0xf
    v_mul_f32_dpp v241, v235, v236 row_newbcast:12 row_mask:0xf bank_mask:0xf
    v_mul_f32 v242, v232, v239
    v_mul_f32 v243, v232, v238
    v_fmac_f32_dpp v240, -v235, v235 row_newbcast:12 row_mask:0xf bank_mask:0xf
    v_fmac_f32_dpp v241, v236, v235 row_newbcast:12 row_mask:0xf bank_mask:0xf
    v_fma_f32 v242, -v233, v238, v242
    v_fmac_f32 v243, v233, v239
    v_cvt_pk_bf16_f32 v188, v240, v241
    v_mul_f32_dpp v234, v236, v242 row_newbcast:13 row_mask:0xf bank_mask:0xf
    v_mul_f32_dpp v237, v235, v242 row_newbcast:13 row_mask:0xf bank_mask:0xf
    v_cvt_pk_bf16_f32 v192, v242, -v243
    v_fmac_f32_dpp v234, -v235, v243 row_newbcast:13 row_mask:0xf bank_mask:0xf
    v_fmac_f32_dpp v237, v236, v243 row_newbcast:13 row_mask:0xf bank_mask:0xf
    v_cvt_pk_bf16_f32 v196, v234, -v237
    v_mul_f32_dpp v235, v157, v200 row_newbcast:5 row_mask:0xf bank_mask:0xf
    v_mul_f32_dpp v234, v156, v200 row_newbcast:5 row_mask:0xf bank_mask:0xf
    v_mul_f32_dpp v238, v157, v201 row_newbcast:5 row_mask:0xf bank_mask:0xf
    v_mul_f32_dpp v237, v156, v201 row_newbcast:5 row_mask:0xf bank_mask:0xf
    v_fract_f32 v235, v235
    v_exp_f32 v234, v234
    v_cos_f32 v236, v235
    v_sin_f32 v235, v235
    v_exp_f32 v237, v237
    v_mul_f32 v236, v234, v236
    v_cos_f32 v239, v238
    v_mul_f32 v235, v234, v235
    v_sin_f32 v238, v238
    v_mul_f32_dpp v232, v158, v237 row_newbcast:5 row_mask:0xf bank_mask:0xf
    v_mul_f32_dpp v233, v159, v237 row_newbcast:5 row_mask:0xf bank_mask:0xf
    v_cvt_pk_bf16_f32 v185, v236, v235
    v_mul_f32_dpp v240, v236, v236 row_newbcast:12 row_mask:0xf bank_mask:0xf
    v_mul_f32_dpp v241, v235, v236 row_newbcast:12 row_mask:0xf bank_mask:0xf
    v_mul_f32 v242, v232, v239
    v_mul_f32 v243, v232, v238
    v_fmac_f32_dpp v240, -v235, v235 row_newbcast:12 row_mask:0xf bank_mask:0xf
    v_fmac_f32_dpp v241, v236, v235 row_newbcast:12 row_mask:0xf bank_mask:0xf
    v_fma_f32 v242, -v233, v238, v242
    v_fmac_f32 v243, v233, v239
    v_cvt_pk_bf16_f32 v189, v240, v241
    v_mul_f32_dpp v234, v236, v242 row_newbcast:13 row_mask:0xf bank_mask:0xf
    v_mul_f32_dpp v237, v235, v242 row_newbcast:13 row_mask:0xf bank_mask:0xf
    v_cvt_pk_bf16_f32 v193, v242, -v243
    v_fmac_f32_dpp v234, -v235, v243 row_newbcast:13 row_mask:0xf bank_mask:0xf
    v_fmac_f32_dpp v237, v236, v243 row_newbcast:13 row_mask:0xf bank_mask:0xf
    v_cvt_pk_bf16_f32 v197, v234, -v237
    v_mul_f32_dpp v235, v157, v200 row_newbcast:6 row_mask:0xf bank_mask:0xf
    v_mul_f32_dpp v234, v156, v200 row_newbcast:6 row_mask:0xf bank_mask:0xf
    v_mul_f32_dpp v238, v157, v201 row_newbcast:6 row_mask:0xf bank_mask:0xf
    v_mul_f32_dpp v237, v156, v201 row_newbcast:6 row_mask:0xf bank_mask:0xf
    v_fract_f32 v235, v235
    v_exp_f32 v234, v234
    v_cos_f32 v236, v235
    v_sin_f32 v235, v235
    v_exp_f32 v237, v237
    v_mul_f32 v236, v234, v236
    v_cos_f32 v239, v238
    v_mul_f32 v235, v234, v235
    v_sin_f32 v238, v238
    v_mul_f32_dpp v232, v158, v237 row_newbcast:6 row_mask:0xf bank_mask:0xf
    v_mul_f32_dpp v233, v159, v237 row_newbcast:6 row_mask:0xf bank_mask:0xf
    v_cvt_pk_bf16_f32 v186, v236, v235
    v_mul_f32_dpp v240, v236, v236 row_newbcast:12 row_mask:0xf bank_mask:0xf
    v_mul_f32_dpp v241, v235, v236 row_newbcast:12 row_mask:0xf bank_mask:0xf
    v_mul_f32 v242, v232, v239
    v_mul_f32 v243, v232, v238
    v_fmac_f32_dpp v240, -v235, v235 row_newbcast:12 row_mask:0xf bank_mask:0xf
    v_fmac_f32_dpp v241, v236, v235 row_newbcast:12 row_mask:0xf bank_mask:0xf
    v_fma_f32 v242, -v233, v238, v242
    v_fmac_f32 v243, v233, v239
    v_cvt_pk_bf16_f32 v190, v240, v241
    v_mul_f32_dpp v234, v236, v242 row_newbcast:13 row_mask:0xf bank_mask:0xf
    v_mul_f32_dpp v237, v235, v242 row_newbcast:13 row_mask:0xf bank_mask:0xf
    v_cvt_pk_bf16_f32 v194, v242, -v243
    v_fmac_f32_dpp v234, -v235, v243 row_newbcast:13 row_mask:0xf bank_mask:0xf
    v_fmac_f32_dpp v237, v236, v243 row_newbcast:13 row_mask:0xf bank_mask:0xf
    v_cvt_pk_bf16_f32 v198, v234, -v237
    v_mul_f32_dpp v235, v157, v200 row_newbcast:7 row_mask:0xf bank_mask:0xf
    v_mul_f32_dpp v234, v156, v200 row_newbcast:7 row_mask:0xf bank_mask:0xf
    v_mul_f32_dpp v238, v157, v201 row_newbcast:7 row_mask:0xf bank_mask:0xf
    v_mul_f32_dpp v237, v156, v201 row_newbcast:7 row_mask:0xf bank_mask:0xf
    v_fract_f32 v235, v235
    v_exp_f32 v234, v234
    v_cos_f32 v236, v235
    v_sin_f32 v235, v235
    v_exp_f32 v237, v237
    v_mul_f32 v236, v234, v236
    v_cos_f32 v239, v238
    v_mul_f32 v235, v234, v235
    v_sin_f32 v238, v238
    v_mul_f32_dpp v232, v158, v237 row_newbcast:7 row_mask:0xf bank_mask:0xf
    v_mul_f32_dpp v233, v159, v237 row_newbcast:7 row_mask:0xf bank_mask:0xf
    v_cvt_pk_bf16_f32 v187, v236, v235
    v_mul_f32_dpp v240, v236, v236 row_newbcast:12 row_mask:0xf bank_mask:0xf
    v_mul_f32_dpp v241, v235, v236 row_newbcast:12 row_mask:0xf bank_mask:0xf
    v_mul_f32 v242, v232, v239
    v_mul_f32 v243, v232, v238
    v_fmac_f32_dpp v240, -v235, v235 row_newbcast:12 row_mask:0xf bank_mask:0xf
    v_fmac_f32_dpp v241, v236, v235 row_newbcast:12 row_mask:0xf bank_mask:0xf
    v_fma_f32 v242, -v233, v238, v242
    v_fmac_f32 v243, v233, v239
    v_cvt_pk_bf16_f32 v191, v240, v241
    v_mul_f32_dpp v234, v236, v242 row_newbcast:13 row_mask:0xf bank_mask:0xf
    v_mul_f32_dpp v237, v235, v242 row_newbcast:13 row_mask:0xf bank_mask:0xf
    v_cvt_pk_bf16_f32 v195, v242, -v243
    v_fmac_f32_dpp v234, -v235, v243 row_newbcast:13 row_mask:0xf bank_mask:0xf
    v_fmac_f32_dpp v237, v236, v243 row_newbcast:13 row_mask:0xf bank_mask:0xf
    v_cvt_pk_bf16_f32 v199, v234, -v237
    s_nop 1
    v_mfma_f32_16x16x32_bf16 v[136:139], v[184:187], v[192:195], v[136:139]
    v_mfma_f32_16x16x32_bf16 v[140:143], v[184:187], v[196:199], v[140:143]
    v_mfma_f32_16x16x32_bf16 v[144:147], v[188:191], v[192:195], v[144:147]
    v_mfma_f32_16x16x32_bf16 v[148:151], v[188:191], v[196:199], v[148:151]
    v_mul_f32_dpp v235, v157, v200 row_newbcast:8 row_mask:0xf bank_mask:0xf
    v_mul_f32_dpp v234, v156, v200 row_newbcast:8 row_mask:0xf bank_mask:0xf
    v_mul_f32_dpp v238, v157, v201 row_newbcast:8 row_mask:0xf bank_mask:0xf
    v_mul_f32_dpp v237, v156, v201 row_newbcast:8 row_mask:0xf bank_mask:0xf
    v_fract_f32 v235, v235
    v_exp_f32 v234, v234
    v_cos_f32 v236, v235
    v_sin_f32 v235, v235
    v_exp_f32 v237, v237
    v_mul_f32 v236, v234, v236
    v_cos_f32 v239, v238
    v_mul_f32 v235, v234, v235
    v_sin_f32 v238, v238
    v_mul_f32_dpp v232, v158, v237 row_newbcast:8 row_mask:0xf bank_mask:0xf
    v_mul_f32_dpp v233, v159, v237 row_newbcast:8 row_mask:0xf bank_mask:0xf
    v_cvt_pk_bf16_f32 v184, v236, v235
    v_mul_f32_dpp v240, v236, v236 row_newbcast:12 row_mask:0xf bank_mask:0xf
    v_mul_f32_dpp v241, v235, v236 row_newbcast:12 row_mask:0xf bank_mask:0xf
    v_mul_f32 v242, v232, v239
    v_mul_f32 v243, v232, v238
    v_fmac_f32_dpp v240, -v235, v235 row_newbcast:12 row_mask:0xf bank_mask:0xf
    v_fmac_f32_dpp v241, v236, v235 row_newbcast:12 row_mask:0xf bank_mask:0xf
    v_fma_f32 v242, -v233, v238, v242
    v_fmac_f32 v243, v233, v239
    v_cvt_pk_bf16_f32 v188, v240, v241
    v_mul_f32_dpp v234, v236, v242 row_newbcast:13 row_mask:0xf bank_mask:0xf
    v_mul_f32_dpp v237, v235, v242 row_newbcast:13 row_mask:0xf bank_mask:0xf
    v_cvt_pk_bf16_f32 v192, v242, -v243
    v_fmac_f32_dpp v234, -v235, v243 row_newbcast:13 row_mask:0xf bank_mask:0xf
    v_fmac_f32_dpp v237, v236, v243 row_newbcast:13 row_mask:0xf bank_mask:0xf
    v_cvt_pk_bf16_f32 v196, v234, -v237
    v_mul_f32_dpp v235, v157, v200 row_newbcast:9 row_mask:0xf bank_mask:0xf
    v_mul_f32_dpp v234, v156, v200 row_newbcast:9 row_mask:0xf bank_mask:0xf
    v_mul_f32_dpp v238, v157, v201 row_newbcast:9 row_mask:0xf bank_mask:0xf
    v_mul_f32_dpp v237, v156, v201 row_newbcast:9 row_mask:0xf bank_mask:0xf
    v_fract_f32 v235, v235
    v_exp_f32 v234, v234
    v_cos_f32 v236, v235
    v_sin_f32 v235, v235
    v_exp_f32 v237, v237
    v_mul_f32 v236, v234, v236
    v_cos_f32 v239, v238
    v_mul_f32 v235, v234, v235
    v_sin_f32 v238, v238
    v_mul_f32_dpp v232, v158, v237 row_newbcast:9 row_mask:0xf bank_mask:0xf
    v_mul_f32_dpp v233, v159, v237 row_newbcast:9 row_mask:0xf bank_mask:0xf
    v_cvt_pk_bf16_f32 v185, v236, v235
    v_mul_f32_dpp v240, v236, v236 row_newbcast:12 row_mask:0xf bank_mask:0xf
    v_mul_f32_dpp v241, v235, v236 row_newbcast:12 row_mask:0xf bank_mask:0xf
    v_mul_f32 v242, v232, v239
    v_mul_f32 v243, v232, v238
    v_fmac_f32_dpp v240, -v235, v235 row_newbcast:12 row_mask:0xf bank_mask:0xf
    v_fmac_f32_dpp v241, v236, v235 row_newbcast:12 row_mask:0xf bank_mask:0xf
    v_fma_f32 v242, -v233, v238, v242
    v_fmac_f32 v243, v233, v239
    v_cvt_pk_bf16_f32 v189, v240, v241
    v_mul_f32_dpp v234, v236, v242 row_newbcast:13 row_mask:0xf bank_mask:0xf
    v_mul_f32_dpp v237, v235, v242 row_newbcast:13 row_mask:0xf bank_mask:0xf
    v_cvt_pk_bf16_f32 v193, v242, -v243
    v_fmac_f32_dpp v234, -v235, v243 row_newbcast:13 row_mask:0xf bank_mask:0xf
    v_fmac_f32_dpp v237, v236, v243 row_newbcast:13 row_mask:0xf bank_mask:0xf
    v_cvt_pk_bf16_f32 v197, v234, -v237
    v_mul_f32_dpp v235, v157, v200 row_newbcast:10 row_mask:0xf bank_mask:0xf
    v_mul_f32_dpp v234, v156, v200 row_newbcast:10 row_mask:0xf bank_mask:0xf
    v_mul_f32_dpp v238, v157, v201 row_newbcast:10 row_mask:0xf bank_mask:0xf
    v_mul_f32_dpp v237, v156, v201 row_newbcast:10 row_mask:0xf bank_mask:0xf
    v_fract_f32 v235, v235
    v_exp_f32 v234, v234
    v_cos_f32 v236, v235
    v_sin_f32 v235, v235
    v_exp_f32 v237, v237
    v_mul_f32 v236, v234, v236
    v_cos_f32 v239, v238
    v_mul_f32 v235, v234, v235
    v_sin_f32 v238, v238
    v_mul_f32_dpp v232, v158, v237 row_newbcast:10 row_mask:0xf bank_mask:0xf
    v_mul_f32_dpp v233, v159, v237 row_newbcast:10 row_mask:0xf bank_mask:0xf
    v_cvt_pk_bf16_f32 v186, v236, v235
    v_mul_f32_dpp v240, v236, v236 row_newbcast:12 row_mask:0xf bank_mask:0xf
    v_mul_f32_dpp v241, v235, v236 row_newbcast:12 row_mask:0xf bank_mask:0xf
    v_mul_f32 v242, v232, v239
    v_mul_f32 v243, v232, v238
    v_fmac_f32_dpp v240, -v235, v235 row_newbcast:12 row_mask:0xf bank_mask:0xf
    v_fmac_f32_dpp v241, v236, v235 row_newbcast:12 row_mask:0xf bank_mask:0xf
    v_fma_f32 v242, -v233, v238, v242
    v_fmac_f32 v243, v233, v239
    v_cvt_pk_bf16_f32 v190, v240, v241
    v_mul_f32_dpp v234, v236, v242 row_newbcast:13 row_mask:0xf bank_mask:0xf
    v_mul_f32_dpp v237, v235, v242 row_newbcast:13 row_mask:0xf bank_mask:0xf
    v_cvt_pk_bf16_f32 v194, v242, -v243
    v_fmac_f32_dpp v234, -v235, v243 row_newbcast:13 row_mask:0xf bank_mask:0xf
    v_fmac_f32_dpp v237, v236, v243 row_newbcast:13 row_mask:0xf bank_mask:0xf
    v_cvt_pk_bf16_f32 v198, v234, -v237
    v_mul_f32_dpp v235, v157, v200 row_newbcast:11 row_mask:0xf bank_mask:0xf
    v_mul_f32_dpp v234, v156, v200 row_newbcast:11 row_mask:0xf bank_mask:0xf
    v_mul_f32_dpp v238, v157, v201 row_newbcast:11 row_mask:0xf bank_mask:0xf
    v_mul_f32_dpp v237, v156, v201 row_newbcast:11 row_mask:0xf bank_mask:0xf
    v_fract_f32 v235, v235
    v_exp_f32 v234, v234
    v_cos_f32 v236, v235
    v_sin_f32 v235, v235
    v_exp_f32 v237, v237
    v_mul_f32 v236, v234, v236
    v_cos_f32 v239, v238
    v_mul_f32 v235, v234, v235
    v_sin_f32 v238, v238
    v_mul_f32_dpp v232, v158, v237 row_newbcast:11 row_mask:0xf bank_mask:0xf
    v_mul_f32_dpp v233, v159, v237 row_newbcast:11 row_mask:0xf bank_mask:0xf
    v_cvt_pk_bf16_f32 v187, v236, v235
    v_mul_f32_dpp v240, v236, v236 row_newbcast:12 row_mask:0xf bank_mask:0xf
    v_mul_f32_dpp v241, v235, v236 row_newbcast:12 row_mask:0xf bank_mask:0xf
    v_mul_f32 v242, v232, v239
    v_mul_f32 v243, v232, v238
    v_fmac_f32_dpp v240, -v235, v235 row_newbcast:12 row_mask:0xf bank_mask:0xf
    v_fmac_f32_dpp v241, v236, v235 row_newbcast:12 row_mask:0xf bank_mask:0xf
    v_fma_f32 v242, -v233, v238, v242
    v_fmac_f32 v243, v233, v239
    v_cvt_pk_bf16_f32 v191, v240, v241
    v_mul_f32_dpp v234, v236, v242 row_newbcast:13 row_mask:0xf bank_mask:0xf
    v_mul_f32_dpp v237, v235, v242 row_newbcast:13 row_mask:0xf bank_mask:0xf
    v_cvt_pk_bf16_f32 v195, v242, -v243
    v_fmac_f32_dpp v234, -v235, v243 row_newbcast:13 row_mask:0xf bank_mask:0xf
    v_fmac_f32_dpp v237, v236, v243 row_newbcast:13 row_mask:0xf bank_mask:0xf
    v_cvt_pk_bf16_f32 v199, v234, -v237
    s_nop 1
    v_mfma_f32_16x16x32_bf16 v[136:139], v[184:187], v[192:195], v[136:139]
    v_mfma_f32_16x16x32_bf16 v[140:143], v[184:187], v[196:199], v[140:143]
    v_mfma_f32_16x16x32_bf16 v[144:147], v[188:191], v[192:195], v[144:147]
    v_mfma_f32_16x16x32_bf16 v[148:151], v[188:191], v[196:199], v[148:151]
    v_mul_f32_dpp v235, v157, v200 row_newbcast:12 row_mask:0xf bank_mask:0xf
    v_mul_f32_dpp v234, v156, v200 row_newbcast:12 row_mask:0xf bank_mask:0xf
    v_mul_f32_dpp v238, v157, v201 row_newbcast:12 row_mask:0xf bank_mask:0xf
    v_mul_f32_dpp v237, v156, v201 row_newbcast:12 row_mask:0xf bank_mask:0xf
    v_fract_f32 v235, v235
    v_exp_f32 v234, v234
    v_cos_f32 v236, v235
    v_sin_f32 v235, v235
    v_exp_f32 v237, v237
    v_mul_f32 v236, v234, v236
    v_cos_f32 v239, v238
    v_mul_f32 v235, v234, v235
    v_sin_f32 v238, v238
    v_mul_f32_dpp v232, v158, v237 row_newbcast:12 row_mask:0xf bank_mask:0xf
    v_mul_f32_dpp v233, v159, v237 row_newbcast:12 row_mask:0xf bank_mask:0xf
    v_cvt_pk_bf16_f32 v184, v236, v235
    v_mul_f32_dpp v240, v236, v236 row_newbcast:12 row_mask:0xf bank_mask:0xf
    v_mul_f32_dpp v241, v235, v236 row_newbcast:12 row_mask:0xf bank_mask:0xf
    v_mul_f32 v242, v232, v239
    v_mul_f32 v243, v232, v238
    v_fmac_f32_dpp v240, -v235, v235 row_newbcast:12 row_mask:0xf bank_mask:0xf
    v_fmac_f32_dpp v241, v236, v235 row_newbcast:12 row_mask:0xf bank_mask:0xf
    v_fma_f32 v242, -v233, v238, v242
    v_fmac_f32 v243, v233, v239
    v_cvt_pk_bf16_f32 v188, v240, v241
    v_mul_f32_dpp v234, v236, v242 row_newbcast:13 row_mask:0xf bank_mask:0xf
    v_mul_f32_dpp v237, v235, v242 row_newbcast:13 row_mask:0xf bank_mask:0xf
    v_cvt_pk_bf16_f32 v192, v242, -v243
    v_fmac_f32_dpp v234, -v235, v243 row_newbcast:13 row_mask:0xf bank_mask:0xf
    v_fmac_f32_dpp v237, v236, v243 row_newbcast:13 row_mask:0xf bank_mask:0xf
    v_cvt_pk_bf16_f32 v196, v234, -v237
    v_mul_f32_dpp v235, v157, v200 row_newbcast:13 row_mask:0xf bank_mask:0xf
    v_mul_f32_dpp v234, v156, v200 row_newbcast:13 row_mask:0xf bank_mask:0xf
    v_mul_f32_dpp v238, v157, v201 row_newbcast:13 row_mask:0xf bank_mask:0xf
    v_mul_f32_dpp v237, v156, v201 row_newbcast:13 row_mask:0xf bank_mask:0xf
    v_fract_f32 v235, v235
    v_exp_f32 v234, v234
    v_cos_f32 v236, v235
    v_sin_f32 v235, v235
    v_exp_f32 v237, v237
    v_mul_f32 v236, v234, v236
    v_cos_f32 v239, v238
    v_mul_f32 v235, v234, v235
    v_sin_f32 v238, v238
    v_mul_f32_dpp v232, v158, v237 row_newbcast:13 row_mask:0xf bank_mask:0xf
    v_mul_f32_dpp v233, v159, v237 row_newbcast:13 row_mask:0xf bank_mask:0xf
    v_cvt_pk_bf16_f32 v185, v236, v235
    v_mul_f32_dpp v240, v236, v236 row_newbcast:12 row_mask:0xf bank_mask:0xf
    v_mul_f32_dpp v241, v235, v236 row_newbcast:12 row_mask:0xf bank_mask:0xf
    v_mul_f32 v242, v232, v239
    v_mul_f32 v243, v232, v238
    v_fmac_f32_dpp v240, -v235, v235 row_newbcast:12 row_mask:0xf bank_mask:0xf
    v_fmac_f32_dpp v241, v236, v235 row_newbcast:12 row_mask:0xf bank_mask:0xf
    v_fma_f32 v242, -v233, v238, v242
    v_fmac_f32 v243, v233, v239
    v_cvt_pk_bf16_f32 v189, v240, v241
    v_mul_f32_dpp v234, v236, v242 row_newbcast:13 row_mask:0xf bank_mask:0xf
    v_mul_f32_dpp v237, v235, v242 row_newbcast:13 row_mask:0xf bank_mask:0xf
    v_cvt_pk_bf16_f32 v193, v242, -v243
    v_fmac_f32_dpp v234, -v235, v243 row_newbcast:13 row_mask:0xf bank_mask:0xf
    v_fmac_f32_dpp v237, v236, v243 row_newbcast:13 row_mask:0xf bank_mask:0xf
    v_cvt_pk_bf16_f32 v197, v234, -v237
    v_mul_f32_dpp v235, v157, v200 row_newbcast:14 row_mask:0xf bank_mask:0xf
    v_mul_f32_dpp v234, v156, v200 row_newbcast:14 row_mask:0xf bank_mask:0xf
    v_mul_f32_dpp v238, v157, v201 row_newbcast:14 row_mask:0xf bank_mask:0xf
    v_mul_f32_dpp v237, v156, v201 row_newbcast:14 row_mask:0xf bank_mask:0xf
    v_fract_f32 v235, v235
    v_exp_f32 v234, v234
    v_cos_f32 v236, v235
    v_sin_f32 v235, v235
    v_exp_f32 v237, v237
    v_mul_f32 v236, v234, v236
    v_cos_f32 v239, v238
    v_mul_f32 v235, v234, v235
    v_sin_f32 v238, v238
    v_mul_f32_dpp v232, v158, v237 row_newbcast:14 row_mask:0xf bank_mask:0xf
    v_mul_f32_dpp v233, v159, v237 row_newbcast:14 row_mask:0xf bank_mask:0xf
    v_cvt_pk_bf16_f32 v186, v236, v235
    v_mul_f32_dpp v240, v236, v236 row_newbcast:12 row_mask:0xf bank_mask:0xf
    v_mul_f32_dpp v241, v235, v236 row_newbcast:12 row_mask:0xf bank_mask:0xf
    v_mul_f32 v242, v232, v239
    v_mul_f32 v243, v232, v238
    v_fmac_f32_dpp v240, -v235, v235 row_newbcast:12 row_mask:0xf bank_mask:0xf
    v_fmac_f32_dpp v241, v236, v235 row_newbcast:12 row_mask:0xf bank_mask:0xf
    v_fma_f32 v242, -v233, v238, v242
    v_fmac_f32 v243, v233, v239
    v_cvt_pk_bf16_f32 v190, v240, v241
    v_mul_f32_dpp v234, v236, v242 row_newbcast:13 row_mask:0xf bank_mask:0xf
    v_mul_f32_dpp v237, v235, v242 row_newbcast:13 row_mask:0xf bank_mask:0xf
    v_cvt_pk_bf16_f32 v194, v242, -v243
    v_fmac_f32_dpp v234, -v235, v243 row_newbcast:13 row_mask:0xf bank_mask:0xf
    v_fmac_f32_dpp v237, v236, v243 row_newbcast:13 row_mask:0xf bank_mask:0xf
    v_cvt_pk_bf16_f32 v198, v234, -v237
    v_mul_f32_dpp v235, v157, v200 row_newbcast:15 row_mask:0xf bank_mask:0xf
    v_mul_f32_dpp v234, v156, v200 row_newbcast:15 row_mask:0xf bank_mask:0xf
    v_mul_f32_dpp v238, v157, v201 row_newbcast:15 row_mask:0xf bank_mask:0xf
    v_mul_f32_dpp v237, v156, v201 row_newbcast:15 row_mask:0xf bank_mask:0xf
    v_fract_f32 v235, v235
    v_exp_f32 v234, v234
    v_cos_f32 v236, v235
    v_sin_f32 v235, v235
    v_exp_f32 v237, v237
    v_mul_f32 v236, v234, v236
    v_cos_f32 v239, v238
    v_mul_f32 v235, v234, v235
    v_sin_f32 v238, v238
    v_mul_f32_dpp v232, v158, v237 row_newbcast:15 row_mask:0xf bank_mask:0xf
    v_mul_f32_dpp v233, v159, v237 row_newbcast:15 row_mask:0xf bank_mask:0xf
    v_cvt_pk_bf16_f32 v187, v236, v235
    v_mul_f32_dpp v240, v236, v236 row_newbcast:12 row_mask:0xf bank_mask:0xf
    v_mul_f32_dpp v241, v235, v236 row_newbcast:12 row_mask:0xf bank_mask:0xf
    v_mul_f32 v242, v232, v239
    v_mul_f32 v243, v232, v238
    v_fmac_f32_dpp v240, -v235, v235 row_newbcast:12 row_mask:0xf bank_mask:0xf
    v_fmac_f32_dpp v241, v236, v235 row_newbcast:12 row_mask:0xf bank_mask:0xf
    v_fma_f32 v242, -v233, v238, v242
    v_fmac_f32 v243, v233, v239
    v_cvt_pk_bf16_f32 v191, v240, v241
    v_mul_f32_dpp v234, v236, v242 row_newbcast:13 row_mask:0xf bank_mask:0xf
    v_mul_f32_dpp v237, v235, v242 row_newbcast:13 row_mask:0xf bank_mask:0xf
    v_cvt_pk_bf16_f32 v195, v242, -v243
    v_fmac_f32_dpp v234, -v235, v243 row_newbcast:13 row_mask:0xf bank_mask:0xf
    v_fmac_f32_dpp v237, v236, v243 row_newbcast:13 row_mask:0xf bank_mask:0xf
    v_cvt_pk_bf16_f32 v199, v234, -v237
    s_nop 1
    v_mfma_f32_16x16x32_bf16 v[136:139], v[184:187], v[192:195], v[136:139]
    v_mfma_f32_16x16x32_bf16 v[140:143], v[184:187], v[196:199], v[140:143]
    v_mfma_f32_16x16x32_bf16 v[144:147], v[188:191], v[192:195], v[144:147]
    v_mfma_f32_16x16x32_bf16 v[148:151], v[188:191], v[196:199], v[148:151]
    v_cmp_eq_u32 vcc, 0, v1
    v_mov_b32 v242, s101
    v_lshlrev_b32 v243, 4, v1
    v_cndmask_b32 v242, 0, v242, vcc
    s_lshl_b32 s3, s83, 11
    s_add_u32 s3, s3, 42467328
    s_nop 7
    s_nop 3
    v_add_f32 v136, v136, v242
    v_cvt_pk_bf16_f32 v232, v136, v137
    v_cvt_pk_bf16_f32 v233, v138, v139
    v_cvt_pk_bf16_f32 v234, v140, v141
    v_cvt_pk_bf16_f32 v235, v142, v143
    v_cvt_pk_bf16_f32 v236, v144, v145
    v_cvt_pk_bf16_f32 v237, v146, v147
    v_cvt_pk_bf16_f32 v238, v148, v149
    v_cvt_pk_bf16_f32 v239, v150, v151
    buffer_store_dwordx4 v[232:235], v243, s[16:19], s3 offen offset:0 sc1
    buffer_store_dwordx4 v[236:239], v243, s[16:19], s3 offen offset:1024 sc1
K1_KG_9:
    v_cmp_gt_u32 vcc, 32, v0
    v_mov_b32 v40, -32
    v_mov_b32 v41, 256
    v_cndmask_b32 v40, v40, v41, vcc
    s_sub_u32 s45, s39, 1
    v_and_b32 v40, s45, v40
    v_add_u32 v40, v40, v0
    v_min_u32 v40, 287, v40
    v_lshlrev_b32 v40, 1, v40
    buffer_load_ushort v41, v40, s[20:23], s42 offen
    v_min_u32 v43, 359, v0
    v_mul_u32_u24 v44, 205, v43
    v_lshrrev_b32 v44, 10, v44
    v_mul_u32_u24 v45, 5, v44
    v_sub_u32 v43, v43, v45
    v_mul_u32_u24 v44, 9216, v44
    v_lshl_add_u32 v43, v43, 7, v44
    s_and_b32 s46, s28, 7
    s_mul_i32 s38, s46, 663552
    s_and_b32 s45, s42, 0xffffff80
    s_add_u32 s38, s38, s45
    buffer_load_dword v255, v43, s[8:11], s38 offen
    v_bfe_u32 v46, v1, 1, 3
    v_xor_b32 v46, s24, v46
    v_lshlrev_b32 v46, 4, v46
    v_lshl_add_u32 v46, v3, 7, v46
    v_lshl_add_u32 v46, v2, 12, v46
    s_sub_u32 s51, s27, 7
    s_lshl_b32 s38, s51, 14
    v_add_u32 v46, s38, v46
    v_add_u32 v47, 8, v46
    v_lshlrev_b32 v48, 4, v1
    s_lshl_b32 s52, s51, 18
    s_lshl_b32 s38, s24, 15
    s_add_u32 s52, s52, s38
    s_lshl_b32 s38, s28, 10
    s_add_u32 s52, s52, s38
    s_add_u32 s52, s52, 37748736
    s_add_u32 s53, s52, 16384
    v_and_b32 v44, 31, v1
    v_bfe_u32 v43, v1, 1, 3
    v_xor_b32 v43, v43, v39
    s_lshl_b32 s38, s26, 5
    v_add_u32 v70, s38, v44
    v_lshlrev_b32 v44, 7, v70
    s_mul_i32 s38, s25, 6
    s_add_u32 s38, s38, 0
    s_and_b32 s45, s38, 3
    s_lshl_b32 s45, s45, 1
    s_lshr_b32 s38, s38, 2
    s_lshl_b32 s38, s38, 14
    v_xor_b32 v45, s45, v43
    v_lshl_add_u32 v45, v45, 4, v44
    v_add_u32 v96, s38, v45
    s_mul_i32 s38, s25, 6
    s_add_u32 s38, s38, 1
    s_and_b32 s45, s38, 3
    s_lshl_b32 s45, s45, 1
    s_lshr_b32 s38, s38, 2
    s_lshl_b32 s38, s38, 14
    v_xor_b32 v45, s45, v43
    v_lshl_add_u32 v45, v45, 4, v44
    v_add_u32 v97, s38, v45
    s_mul_i32 s38, s25, 6
    s_add_u32 s38, s38, 2
    s_and_b32 s45, s38, 3
    s_lshl_b32 s45, s45, 1
    s_lshr_b32 s38, s38, 2
    s_lshl_b32 s38, s38, 14
    v_xor_b32 v45, s45, v43
    v_lshl_add_u32 v45, v45, 4, v44
    v_add_u32 v98, s38, v45
    s_mul_i32 s38, s25, 6
    s_add_u32 s38, s38, 3
    s_and_b32 s45, s38, 3
    s_lshl_b32 s45, s45, 1
    s_lshr_b32 s38, s38, 2
    s_lshl_b32 s38, s38, 14
    v_xor_b32 v45, s45, v43
    v_lshl_add_u32 v45, v45, 4, v44
    v_add_u32 v99, s38, v45
    s_mul_i32 s38, s25, 6
    s_add_u32 s38, s38, 4
    s_and_b32 s45, s38, 3
    s_lshl_b32 s45, s45, 1
    s_lshr_b32 s38, s38, 2
    s_lshl_b32 s38, s38, 14
    v_xor_b32 v45, s45, v43
    v_lshl_add_u32 v45, v45, 4, v44
    v_add_u32 v100, s38, v45
    s_mul_i32 s38, s25, 6
    s_add_u32 s38, s38, 5
    s_and_b32 s45, s38, 3
    s_lshl_b32 s45, s45, 1
    s_lshr_b32 s38, s38, 2
    s_lshl_b32 s38, s38, 14
    v_xor_b32 v45, s45, v43
    v_lshl_add_u32 v45, v45, 4, v44
    v_add_u32 v101, s38, v45
    v_lshrrev_b32 v43, 1, v38
    v_lshl_add_u32 v43, v2, 2, v43
    v_and_b32 v44, 1, v38
    v_lshl_add_u32 v43, v44, 4, v43
    v_bfe_u32 v44, v1, 1, 1
    s_and_b32 s38, s24, 6
    v_or_b32 v44, s38, v44
    v_lshlrev_b32 v45, 1, v2
    v_xor_b32 v44, v44, v45
    v_lshlrev_b32 v43, 7, v43
    v_and_b32 v45, 1, v1
    v_lshl_add_u32 v43, v45, 3, v43
    s_and_b32 s38, s24, 1
    s_lshl_b32 s38, s38, 13
    s_lshl_b32 s45, s27, 14
    s_add_u32 s38, s38, s45
    v_add_u32 v43, s38, v43
    v_lshl_add_u32 v71, v44, 4, v43
    v_xor_b32 v102, 16, v71
    v_mov_b32 v104, 0
    v_mov_b32 v105, 0
    v_mov_b32 v106, 0
    v_mov_b32 v50, s43
    v_mov_b32 v51, s43
    v_mov_b32 v52, s43
    v_mov_b32 v53, s43
    s_waitcnt vmcnt(14)
    s_barrier
    ds_read_b128 v[112:115], v96
    ds_read_b128 v[116:119], v97
    ds_read_b128 v[120:123], v98
    ds_read_b128 v[124:127], v99
    ds_read_b128 v[128:131], v100
    ds_read_b128 v[132:135], v101
    v_add_u32 v96, 49152, v96
    v_add_u32 v97, 49152, v97
    v_add_u32 v98, 49152, v98
    v_add_u32 v99, 49152, v99
    v_add_u32 v100, 49152, v100
    v_add_u32 v101, 49152, v101
    s_sub_u32 s38, s27, 0
    s_cmp_lt_u32 s38, 3
    s_cbranch_scc0 K1_XT_10
    ds_read_b64_tr_b16 v[26:27], v71 offset:0
    ds_read_b64_tr_b16 v[28:29], v102 offset:256
    ds_read_b64_tr_b16 v[30:31], v71 offset:4096
    ds_read_b64_tr_b16 v[32:33], v102 offset:4352
    s_waitcnt lgkmcnt(0)
K1_XT_10:
    s_sub_u32 s38, s51, 0
    s_cmp_lt_u32 s38, 3
    s_cbranch_scc0 K1_X4_11
    ds_read2st64_b64 v[88:91], v46 offset0:0 offset1:4
    ds_read2st64_b64 v[92:95], v47 offset0:0 offset1:4
    s_waitcnt lgkmcnt(0)
    buffer_store_dwordx4 v[88:91], v48, s[16:19], s52 offen sc1
    buffer_store_dwordx4 v[92:95], v48, s[16:19], s53 offen sc1
K1_X4_11:
    s_waitcnt lgkmcnt(5)
    v_mfma_f32_32x32x16_bf16 v[72:87], v[50:53], v[112:115], 0
    v_dot2_f32_bf16 v105, v112, v112, v105
    v_dot2_f32_bf16 v106, v113, v113, v106
    v_dot2_f32_bf16 v105, v114, v114, v105
    v_dot2_f32_bf16 v106, v115, v115, v106
    s_waitcnt lgkmcnt(4)
    v_mfma_f32_32x32x16_bf16 v[72:87], v[50:53], v[116:119], v[72:87]
    v_dot2_f32_bf16 v105, v116, v116, v105
    v_dot2_f32_bf16 v106, v117, v117, v106
    v_dot2_f32_bf16 v105, v118, v118, v105
    v_dot2_f32_bf16 v106, v119, v119, v106
    s_waitcnt lgkmcnt(3)
    v_mfma_f32_32x32x16_bf16 v[72:87], v[50:53], v[120:123], v[72:87]
    v_dot2_f32_bf16 v105, v120, v120, v105
    v_dot2_f32_bf16 v106, v121, v121, v106
    v_dot2_f32_bf16 v105, v122, v122, v105
    v_dot2_f32_bf16 v106, v123, v123, v106
    s_waitcnt lgkmcnt(2)
    v_mfma_f32_32x32x16_bf16 v[72:87], v[50:53], v[124:127], v[72:87]
    v_dot2_f32_bf16 v105, v124, v124, v105
    v_dot2_f32_bf16 v106, v125, v125, v106
    v_dot2_f32_bf16 v105, v126, v126, v105
    v_dot2_f32_bf16 v106, v127, v127, v106
    s_waitcnt lgkmcnt(1)
    v_mfma_f32_32x32x16_bf16 v[72:87], v[50:53], v[128:131], v[72:87]
    v_dot2_f32_bf16 v105, v128, v128, v105
    v_dot2_f32_bf16 v106, v129, v129, v106
    v_dot2_f32_bf16 v105, v130, v130, v105
    v_dot2_f32_bf16 v106, v131, v131, v106
    s_waitcnt lgkmcnt(0)
    v_mfma_f32_32x32x16_bf16 v[72:87], v[50:53], v[132:135], v[72:87]
    v_dot2_f32_bf16 v105, v132, v132, v105
    v_dot2_f32_bf16 v106, v133, v133, v106
    v_dot2_f32_bf16 v105, v134, v134, v105
    v_dot2_f32_bf16 v106, v135, v135, v106
    s_waitcnt vmcnt(8)
    s_barrier
    ds_read_b128 v[160:163], v96
    ds_read_b128 v[164:167], v97
    ds_read_b128 v[168:171], v98
    ds_read_b128 v[172:175], v99
    ds_read_b128 v[176:179], v100
    ds_read_b128 v[180:183], v101
    s_add_u32 m0, s36, 0
    s_add_u32 s38, s29, 0
    buffer_load_dwordx4 v13, s[8:11], s38 offen lds
    s_add_u32 m0, s36, 12288
    s_add_u32 s38, s29, 884736
    buffer_load_dwordx4 v13, s[8:11], s38 offen lds
    s_add_u32 m0, s50, 0
    s_add_u32 s38, s48, 0
    buffer_load_dwordx4 v13, s[8:11], s38 offen lds
    s_add_u32 m0, s36, 24576
    s_add_u32 s38, s31, 0
    buffer_load_dwordx4 v14, s[8:11], s38 offen lds
    s_add_u32 m0, s36, 36864
    s_add_u32 s38, s31, 1769472
    buffer_load_dwordx4 v14, s[8:11], s38 offen lds
    s_add_u32 m0, s50, 24576
    s_add_u32 s38, s49, 0
    buffer_load_dwordx4 v14, s[8:11], s38 offen lds
    v_add_u32 v96, 49152, v96
    v_add_u32 v97, 49152, v97
    v_add_u32 v98, 49152, v98
    v_add_u32 v99, 49152, v99
    v_add_u32 v100, 49152, v100
    v_add_u32 v101, 49152, v101
    s_sub_u32 s38, s27, 3
    s_cmp_lt_u32 s38, 3
    s_cbranch_scc0 K1_XT_12
    ds_read_b64_tr_b16 v[26:27], v71 offset:0
    ds_read_b64_tr_b16 v[28:29], v102 offset:256
    ds_read_b64_tr_b16 v[30:31], v71 offset:4096
    ds_read_b64_tr_b16 v[32:33], v102 offset:4352
    s_waitcnt lgkmcnt(0)
K1_XT_12:
    s_sub_u32 s38, s51, 3
    s_cmp_lt_u32 s38, 3
    s_cbranch_scc0 K1_X4_13
    ds_read2st64_b64 v[88:91], v46 offset0:0 offset1:4
    ds_read2st64_b64 v[92:95], v47 offset0:0 offset1:4
    s_waitcnt lgkmcnt(0)
    buffer_store_dwordx4 v[88:91], v48, s[16:19], s52 offen sc1
    buffer_store_dwordx4 v[92:95], v48, s[16:19], s53 offen sc1
K1_X4_13:
    s_waitcnt lgkmcnt(5)
    v_mfma_f32_32x32x16_bf16 v[72:87], v[50:53], v[160:163], v[72:87]
    v_dot2_f32_bf16 v105, v160, v160, v105
    v_dot2_f32_bf16 v106, v161, v161, v106
    v_dot2_f32_bf16 v105, v162, v162, v105
    v_dot2_f32_bf16 v106, v163, v163, v106
    s_waitcnt lgkmcnt(4)
    v_mfma_f32_32x32x16_bf16 v[72:87], v[50:53], v[164:167], v[72:87]
    v_dot2_f32_bf16 v105, v164, v164, v105
    v_dot2_f32_bf16 v106, v165, v165, v106
    v_dot2_f32_bf16 v105, v166, v166, v105
    v_dot2_f32_bf16 v106, v167, v167, v106
    s_waitcnt lgkmcnt(3)
    v_mfma_f32_32x32x16_bf16 v[72:87], v[50:53], v[168:171], v[72:87]
    v_dot2_f32_bf16 v105, v168, v168, v105
    v_dot2_f32_bf16 v106, v169, v169, v106
    v_dot2_f32_bf16 v105, v170, v170, v105
    v_dot2_f32_bf16 v106, v171, v171, v106
    s_waitcnt lgkmcnt(2)
    v_mfma_f32_32x32x16_bf16 v[72:87], v[50:53], v[172:175], v[72:87]
    v_dot2_f32_bf16 v105, v172, v172, v105
    v_dot2_f32_bf16 v106, v173, v173, v106
    v_dot2_f32_bf16 v105, v174, v174, v105
    v_dot2_f32_bf16 v106, v175, v175, v106
    s_waitcnt lgkmcnt(1)
    v_mfma_f32_32x32x16_bf16 v[72:87], v[50:53], v[176:179], v[72:87]
    v_dot2_f32_bf16 v105, v176, v176, v105
    v_dot2_f32_bf16 v106, v177, v177, v106
    v_dot2_f32_bf16 v105, v178, v178, v105
    v_dot2_f32_bf16 v106, v179, v179, v106
    s_waitcnt lgkmcnt(0)
    v_mfma_f32_32x32x16_bf16 v[72:87], v[50:53], v[180:183], v[72:87]
    v_dot2_f32_bf16 v105, v180, v180, v105
    v_dot2_f32_bf16 v106, v181, v181, v106
    v_dot2_f32_bf16 v105, v182, v182, v105
    v_dot2_f32_bf16 v106, v183, v183, v106
    s_waitcnt vmcnt(8)
    s_barrier
    ds_read_b128 v[208:211], v96
    ds_read_b128 v[212:215], v97
    ds_read_b128 v[216:219], v98
    ds_read_b128 v[220:223], v99
    ds_read_b128 v[224:227], v100
    ds_read_b128 v[228:231], v101
    s_add_u32 m0, s36, 49152
    s_add_u32 s38, s29, 1769472
    buffer_load_dwordx4 v13, s[8:11], s38 offen lds
    s_add_u32 m0, s36, 61440
    s_add_u32 s38, s29, 2654208
    buffer_load_dwordx4 v13, s[8:11], s38 offen lds
    s_add_u32 m0, s50, 49152
    s_add_u32 s38, s48, 1769472
    buffer_load_dwordx4 v13, s[8:11], s38 offen lds
    s_add_u32 m0, s36, 73728
    s_add_u32 s38, s29, 3538944
    buffer_load_dwordx4 v13, s[8:11], s38 offen lds
    s_add_u32 m0, s36, 86016
    s_add_u32 s38, s29, 4423680
    buffer_load_dwordx4 v13, s[8:11], s38 offen lds
    s_add_u32 m0, s50, 73728
    s_add_u32 s38, s48, 3538944
    buffer_load_dwordx4 v13, s[8:11], s38 offen lds
    s_sub_u32 s38, s27, 6
    s_cmp_lt_u32 s38, 3
    s_cbranch_scc0 K1_XT_14
    ds_read_b64_tr_b16 v[26:27], v71 offset:0
    ds_read_b64_tr_b16 v[28:29], v102 offset:256
    ds_read_b64_tr_b16 v[30:31], v71 offset:4096
    ds_read_b64_tr_b16 v[32:33], v102 offset:4352
    s_waitcnt lgkmcnt(0)
K1_XT_14:
    s_sub_u32 s38, s51, 6
    s_cmp_lt_u32 s38, 3
    s_cbranch_scc0 K1_X4_15
    ds_read2st64_b64 v[88:91], v46 offset0:0 offset1:4
    ds_read2st64_b64 v[92:95], v47 offset0:0 offset1:4
    s_waitcnt lgkmcnt(0)
    buffer_store_dwordx4 v[88:91], v48, s[16:19], s52 offen sc1
    buffer_store_dwordx4 v[92:95], v48, s[16:19], s53 offen sc1
K1_X4_15:
    s_waitcnt lgkmcnt(5)
    v_mfma_f32_32x32x16_bf16 v[72:87], v[50:53], v[208:211], v[72:87]
    v_dot2_f32_bf16 v105, v208, v208, v105
    v_dot2_f32_bf16 v106, v209, v209, v106
    v_dot2_f32_bf16 v105, v210, v210, v105
    v_dot2_f32_bf16 v106, v211, v211, v106
    s_waitcnt lgkmcnt(4)
    v_mfma_f32_32x32x16_bf16 v[72:87], v[50:53], v[212:215], v[72:87]
    v_dot2_f32_bf16 v105, v212, v212, v105
    v_dot2_f32_bf16 v106, v213, v213, v106
    v_dot2_f32_bf16 v105, v214, v214, v105
    v_dot2_f32_bf16 v106, v215, v215, v106
    s_waitcnt lgkmcnt(3)
    v_mfma_f32_32x32x16_bf16 v[72:87], v[50:53], v[216:219], v[72:87]
    v_dot2_f32_bf16 v105, v216, v216, v105
    v_dot2_f32_bf16 v106, v217, v217, v106
    v_dot2_f32_bf16 v105, v218, v218, v105
    v_dot2_f32_bf16 v106, v219, v219, v106
    s_waitcnt lgkmcnt(2)
    v_mfma_f32_32x32x16_bf16 v[72:87], v[50:53], v[220:223], v[72:87]
    v_dot2_f32_bf16 v105, v220, v220, v105
    v_dot2_f32_bf16 v106, v221, v221, v106
    v_dot2_f32_bf16 v105, v222, v222, v105
    v_dot2_f32_bf16 v106, v223, v223, v106
    s_waitcnt lgkmcnt(1)
    v_mfma_f32_32x32x16_bf16 v[72:87], v[50:53], v[224:227], v[72:87]
    v_dot2_f32_bf16 v105, v224, v224, v105
    v_dot2_f32_bf16 v106, v225, v225, v106
    v_dot2_f32_bf16 v105, v226, v226, v105
    v_dot2_f32_bf16 v106, v227, v227, v106
    s_waitcnt lgkmcnt(0)
    v_mfma_f32_32x32x16_bf16 v[72:87], v[50:53], v[228:231], v[72:87]
    v_dot2_f32_bf16 v105, v228, v228, v105
    v_dot2_f32_bf16 v106, v229, v229, v106
    v_dot2_f32_bf16 v105, v230, v230, v105
    v_dot2_f32_bf16 v106, v231, v231, v106
    v_min_u32 v43, 323, v0
    v_lshlrev_b32 v43, 7, v43
    s_and_b32 s46, s28, 7
    s_mul_i32 s38, s27, 331776
    s_mul_i32 s45, s46, 41472
    s_add_u32 s38, s38, s45
    buffer_load_dword v254, v43, s[12:15], s38 offen
    s_waitcnt vmcnt(14)
    v_lshlrev_b32 v41, 16, v41
    v_mov_b32 v39, 0x3eeff558
    v_mov_b32 v38, 0x3e6ff558
    v_cmp_gt_u32 vcc, 32, v0
    v_min_u32 v40, 287, v0
    v_lshlrev_b32 v40, 2, v40
    v_cndmask_b32 v39, v39, v38, vcc
    v_add_u32 v40, 158720, v40
    v_mul_f32 v41, v41, v39
    v_cmp_gt_u32 vcc, 288, v0
    s_and_saveexec_b64 s[54:55], vcc
    ds_write_b32 v40, v41
    s_mov_b64 exec, s[54:55]
    v_add_f32 v105, v105, v106
    v_mov_b32 v34, v105
    s_lshl_b32 s38, s25, 3
    s_add_u32 s38, s38, 155648
    v_lshlrev_b32 v38, 4, v70
    v_permlane32_swap_b32 v105, v34
    v_add_u32 v39, s38, v38
    v_mov_b32 v104, v72
    v_add_f32 v105, v105, v34
    ds_write_b64 v39, v[104:105]
    v_add_u32 v38, 155648, v38
    s_waitcnt lgkmcnt(0)
    s_barrier
    ds_read_b128 v[42:45], v38
    ds_read_b128 v[96:99], v18 offset:128
    ds_read_b128 v[100:103], v18 offset:160
    ds_read_b128 v[104:107], v18 offset:192
    ds_read_b128 v[108:111], v18 offset:224
    ds_read_b128 v[72:75], v19 offset:0
    ds_read_b128 v[76:79], v19 offset:32
    ds_read_b128 v[80:83], v19 offset:64
    ds_read_b128 v[84:87], v19 offset:96
    s_waitcnt lgkmcnt(8)
    v_add_f32 v42, v42, v44
    v_add_f32 v43, v43, v45
    v_mul_f32 v42, 0x3ae38e39, v42
    v_mul_f32 v43, 0x3ae38e39, v43
    v_fma_f32 v43, -v42, v42, v43
    v_max_f32 v43, 0, v43
    v_cvt_pk_bf16_f32 v44, v42, v43
    v_lshlrev_b32 v42, 16, v44
    v_and_b32 v43, s44, v44
    v_add_f32 v43, 0x3727c5ac, v43
    v_cvt_pk_bf16_f32 v43, v43, v43
    v_and_b32 v43, s44, v43
    v_sqrt_f32 v43, v43
    s_nop 0
    v_cvt_pk_bf16_f32 v43, v43, v43
    v_and_b32 v43, s44, v43
    v_rcp_f32 v44, v43
    v_lshlrev_b32 v38, 3, v70
    v_mul_f32 v45, -v42, v44
    v_add_u32 v38, 157696, v38
    v_mul_f32 v22, s47, v44
    v_mul_f32 v23, s47, v45
    ds_write_b64 v38, v[44:45]
    v_lshlrev_b32 v34, 16, v112
    v_and_b32 v35, s44, v112
    v_lshlrev_b32 v36, 16, v113
    v_and_b32 v37, s44, v113
    v_lshlrev_b32 v38, 16, v114
    v_and_b32 v39, s44, v114
    v_lshlrev_b32 v40, 16, v115
    v_and_b32 v41, s44, v115
    v_fma_f32 v34, v34, v22, v23
    v_fma_f32 v35, v35, v22, v23
    v_fma_f32 v36, v36, v22, v23
    v_fma_f32 v37, v37, v22, v23
    v_fma_f32 v38, v38, v22, v23
    v_fma_f32 v39, v39, v22, v23
    v_fma_f32 v40, v40, v22, v23
    v_fma_f32 v41, v41, v22, v23
    v_cvt_pk_bf16_f32 v112, v34, v35
    v_cvt_pk_bf16_f32 v113, v36, v37
    v_cvt_pk_bf16_f32 v114, v38, v39
    v_cvt_pk_bf16_f32 v115, v40, v41
    ds_write_b128 v16, v[112:115] offset:0
    v_lshlrev_b32 v42, 16, v116
    v_and_b32 v43, s44, v116
    v_lshlrev_b32 v44, 16, v117
    v_and_b32 v45, s44, v117
    v_lshlrev_b32 v46, 16, v118
    v_and_b32 v47, s44, v118
    v_lshlrev_b32 v48, 16, v119
    v_and_b32 v49, s44, v119
    v_fma_f32 v42, v42, v22, v23
    v_fma_f32 v43, v43, v22, v23
    v_fma_f32 v44, v44, v22, v23
    v_fma_f32 v45, v45, v22, v23
    v_fma_f32 v46, v46, v22, v23
    v_fma_f32 v47, v47, v22, v23
    v_fma_f32 v48, v48, v22, v23
    v_fma_f32 v49, v49, v22, v23
    v_cvt_pk_bf16_f32 v116, v42, v43
    v_cvt_pk_bf16_f32 v117, v44, v45
    v_cvt_pk_bf16_f32 v118, v46, v47
    v_cvt_pk_bf16_f32 v119, v48, v49
    ds_write_b128 v16, v[116:119] offset:1024
    s_waitcnt vmcnt(7) lgkmcnt(0)
    s_barrier
    ds_read_b64_tr_b16 v[50:51], v8 offset:24576
    ds_read_b64_tr_b16 v[52:53], v8 offset:25088
    ds_read_b64_tr_b16 v[54:55], v4 offset:0
    ds_read_b64_tr_b16 v[56:57], v4 offset:512
    ds_read_b64_tr_b16 v[58:59], v8 offset:26624
    ds_read_b64_tr_b16 v[60:61], v8 offset:27136
    ds_read_b64_tr_b16 v[62:63], v4 offset:2048
    ds_read_b64_tr_b16 v[64:65], v4 offset:2560
    ds_read_b128 v[136:139], v21 offset:0
    ds_read_b128 v[140:143], v21 offset:1024
    s_setprio 3
    s_waitcnt lgkmcnt(8)
    v_mfma_f32_32x32x16_bf16 v[72:87], v[50:53], v[112:115], v[72:87]
    ds_read_b64_tr_b16 v[66:67], v6 offset:0
    ds_read_b64_tr_b16 v[68:69], v6 offset:512
    v_lshlrev_b32 v34, 16, v120
    v_and_b32 v35, s44, v120
    v_lshlrev_b32 v36, 16, v121
    v_and_b32 v37, s44, v121
    v_lshlrev_b32 v38, 16, v122
    v_and_b32 v39, s44, v122
    v_lshlrev_b32 v40, 16, v123
    v_and_b32 v41, s44, v123
    v_fma_f32 v34, v34, v22, v23
    s_waitcnt lgkmcnt(8)
    v_mfma_f32_32x32x16_bf16 v[96:111], v[54:57], v[112:115], v[96:111]
    ds_read_b64_tr_b16 v[50:51], v6 offset:2048
    ds_read_b64_tr_b16 v[52:53], v6 offset:2560
    v_fma_f32 v35, v35, v22, v23
    v_fma_f32 v36, v36, v22, v23
    v_fma_f32 v37, v37, v22, v23
    v_fma_f32 v38, v38, v22, v23
    v_fma_f32 v39, v39, v22, v23
    v_fma_f32 v40, v40, v22, v23
    v_fma_f32 v41, v41, v22, v23
    v_cvt_pk_bf16_f32 v120, v34, v35
    v_cvt_pk_bf16_f32 v121, v36, v37
    s_setprio 2
    s_waitcnt lgkmcnt(8)
    v_mfma_f32_32x32x16_bf16 v[72:87], v[58:61], v[116:119], v[72:87]
    ds_read_b64_tr_b16 v[54:55], v8 offset:28672
    ds_read_b64_tr_b16 v[56:57], v8 offset:29184
    v_cvt_pk_bf16_f32 v122, v38, v39
    v_cvt_pk_bf16_f32 v123, v40, v41
    ds_write_b128 v16, v[120:123] offset:16384
    v_lshlrev_b32 v42, 16, v124
    v_and_b32 v43, s44, v124
    v_lshlrev_b32 v44, 16, v125
    v_and_b32 v45, s44, v125
    v_lshlrev_b32 v46, 16, v126
    s_setprio 1
    s_waitcnt lgkmcnt(9)
    v_mfma_f32_32x32x16_bf16 v[96:111], v[62:65], v[116:119], v[96:111]
    ds_read_b64_tr_b16 v[58:59], v4 offset:4096
    ds_read_b64_tr_b16 v[60:61], v4 offset:4608
    v_and_b32 v47, s44, v126
    v_lshlrev_b32 v48, 16, v127
    v_and_b32 v49, s44, v127
    v_fma_f32 v42, v42, v22, v23
    v_fma_f32 v43, v43, v22, v23
    v_fma_f32 v44, v44, v22, v23
    v_fma_f32 v45, v45, v22, v23
    v_fma_f32 v46, v46, v22, v23
    s_waitcnt lgkmcnt(7)
    v_mfma_f32_32x32x16_bf16 v[96:111], v[66:69], v[136:139], v[96:111]
    ds_read_b64_tr_b16 v[62:63], v8 offset:30720
    ds_read_b64_tr_b16 v[64:65], v8 offset:31232
    v_fma_f32 v47, v47, v22, v23
    v_fma_f32 v48, v48, v22, v23
    v_fma_f32 v49, v49, v22, v23
    v_cvt_pk_bf16_f32 v124, v42, v43
    v_cvt_pk_bf16_f32 v125, v44, v45
    v_cvt_pk_bf16_f32 v126, v46, v47
    v_cvt_pk_bf16_f32 v127, v48, v49
    ds_write_b128 v16, v[124:127] offset:17408
    s_setprio 0
    s_waitcnt lgkmcnt(8)
    v_mfma_f32_32x32x16_bf16 v[96:111], v[50:53], v[140:143], v[96:111]
    ds_read_b64_tr_b16 v[66:67], v4 offset:6144
    ds_read_b64_tr_b16 v[68:69], v4 offset:6656
    s_waitcnt lgkmcnt(2)
    s_barrier
    ds_read_b128 v[144:147], v21 offset:16384
    ds_read_b128 v[148:151], v21 offset:17408
    s_setprio 3
    v_mfma_f32_32x32x16_bf16 v[72:87], v[54:57], v[120:123], v[72:87]
    ds_read_b64_tr_b16 v[50:51], v6 offset:4096
    ds_read_b64_tr_b16 v[52:53], v6 offset:4608
    v_lshlrev_b32 v34, 16, v128
    v_and_b32 v35, s44, v128
    v_lshlrev_b32 v36, 16, v129
    v_and_b32 v37, s44, v129
    v_lshlrev_b32 v38, 16, v130
    v_and_b32 v39, s44, v130
    v_lshlrev_b32 v40, 16, v131
    v_and_b32 v41, s44, v131
    v_fma_f32 v34, v34, v22, v23
    v_mfma_f32_32x32x16_bf16 v[96:111], v[58:61], v[120:123], v[96:111]
    ds_read_b64_tr_b16 v[54:55], v6 offset:6144
    ds_read_b64_tr_b16 v[56:57], v6 offset:6656
    v_fma_f32 v35, v35, v22, v23
    v_fma_f32 v36, v36, v22, v23
    v_fma_f32 v37, v37, v22, v23
    v_fma_f32 v38, v38, v22, v23
    v_fma_f32 v39, v39, v22, v23
    v_fma_f32 v40, v40, v22, v23
    v_fma_f32 v41, v41, v22, v23
    v_cvt_pk_bf16_f32 v128, v34, v35
    v_cvt_pk_bf16_f32 v129, v36, v37
    s_setprio 2
    v_mfma_f32_32x32x16_bf16 v[72:87], v[62:65], v[124:127], v[72:87]
    ds_read_b64_tr_b16 v[58:59], v8 offset:32768
    ds_read_b64_tr_b16 v[60:61], v8 offset:33280
    v_cvt_pk_bf16_f32 v130, v38, v39
    v_cvt_pk_bf16_f32 v131, v40, v41
    ds_write_b128 v16, v[128:131] offset:0
    v_lshlrev_b32 v42, 16, v132
    v_and_b32 v43, s44, v132
    v_lshlrev_b32 v44, 16, v133
    v_and_b32 v45, s44, v133
    v_lshlrev_b32 v46, 16, v134
    s_setprio 1
    s_waitcnt lgkmcnt(9)
    v_mfma_f32_32x32x16_bf16 v[96:111], v[66:69], v[124:127], v[96:111]
    ds_read_b64_tr_b16 v[62:63], v4 offset:8192
    ds_read_b64_tr_b16 v[64:65], v4 offset:8704
    v_and_b32 v47, s44, v134
    v_lshlrev_b32 v48, 16, v135
    v_and_b32 v49, s44, v135
    v_fma_f32 v42, v42, v22, v23
    v_fma_f32 v43, v43, v22, v23
    v_fma_f32 v44, v44, v22, v23
    v_fma_f32 v45, v45, v22, v23
    v_fma_f32 v46, v46, v22, v23
    s_waitcnt lgkmcnt(7)
    v_mfma_f32_32x32x16_bf16 v[96:111], v[50:53], v[144:147], v[96:111]
    ds_read_b64_tr_b16 v[66:67], v8 offset:34816
    ds_read_b64_tr_b16 v[68:69], v8 offset:35328
    v_fma_f32 v47, v47, v22, v23
    v_fma_f32 v48, v48, v22, v23
    v_fma_f32 v49, v49, v22, v23
    v_cvt_pk_bf16_f32 v132, v42, v43
    v_cvt_pk_bf16_f32 v133, v44, v45
    v_cvt_pk_bf16_f32 v134, v46, v47
    v_cvt_pk_bf16_f32 v135, v48, v49
    ds_write_b128 v16, v[132:135] offset:1024
    s_setprio 0
    s_waitcnt lgkmcnt(8)
    v_mfma_f32_32x32x16_bf16 v[96:111], v[54:57], v[148:151], v[96:111]
    ds_read_b64_tr_b16 v[50:51], v4 offset:10240
    ds_read_b64_tr_b16 v[52:53], v4 offset:10752
    s_waitcnt vmcnt(4) lgkmcnt(2)
    s_barrier
    ds_read_b128 v[152:155], v21 offset:0
    ds_read_b128 v[156:159], v21 offset:1024
    s_setprio 3
    v_mfma_f32_32x32x16_bf16 v[72:87], v[58:61], v[128:131], v[72:87]
    ds_read_b64_tr_b16 v[54:55], v6 offset:8192
    ds_read_b64_tr_b16 v[56:57], v6 offset:8704
    v_lshlrev_b32 v34, 16, v160
    v_and_b32 v35, s44, v160
    v_lshlrev_b32 v36, 16, v161
    v_and_b32 v37, s44, v161
    v_lshlrev_b32 v38, 16, v162
    v_and_b32 v39, s44, v162
    v_lshlrev_b32 v40, 16, v163
    v_and_b32 v41, s44, v163
    v_fma_f32 v34, v34, v22, v23
    v_mfma_f32_32x32x16_bf16 v[96:111], v[62:65], v[128:131], v[96:111]
    ds_read_b64_tr_b16 v[58:59], v6 offset:10240
    ds_read_b64_tr_b16 v[60:61], v6 offset:10752
    v_fma_f32 v35, v35, v22, v23
    v_fma_f32 v36, v36, v22, v23
    v_fma_f32 v37, v37, v22, v23
    v_fma_f32 v38, v38, v22, v23
    v_fma_f32 v39, v39, v22, v23
    v_fma_f32 v40, v40, v22, v23
    v_fma_f32 v41, v41, v22, v23
    v_cvt_pk_bf16_f32 v160, v34, v35
    v_cvt_pk_bf16_f32 v161, v36, v37
    s_setprio 2
    v_mfma_f32_32x32x16_bf16 v[72:87], v[66:69], v[132:135], v[72:87]
    ds_read_b64_tr_b16 v[62:63], v8 offset:36864
    ds_read_b64_tr_b16 v[64:65], v8 offset:37376
    v_cvt_pk_bf16_f32 v162, v38, v39
    v_cvt_pk_bf16_f32 v163, v40, v41
    ds_write_b128 v16, v[160:163] offset:16384
    v_lshlrev_b32 v42, 16, v164
    v_and_b32 v43, s44, v164
    v_lshlrev_b32 v44, 16, v165
    v_and_b32 v45, s44, v165
    v_lshlrev_b32 v46, 16, v166
    s_setprio 1
    s_waitcnt lgkmcnt(9)
    v_mfma_f32_32x32x16_bf16 v[96:111], v[50:53], v[132:135], v[96:111]
    ds_read_b64_tr_b16 v[66:67], v5 offset:0
    ds_read_b64_tr_b16 v[68:69], v5 offset:512
    v_and_b32 v47, s44, v166
    v_lshlrev_b32 v48, 16, v167
    v_and_b32 v49, s44, v167
    v_fma_f32 v42, v42, v22, v23
    v_fma_f32 v43, v43, v22, v23
    v_fma_f32 v44, v44, v22, v23
    v_fma_f32 v45, v45, v22, v23
    v_fma_f32 v46, v46, v22, v23
    s_waitcnt lgkmcnt(7)
    v_mfma_f32_32x32x16_bf16 v[96:111], v[54:57], v[152:155], v[96:111]
    ds_read_b64_tr_b16 v[50:51], v8 offset:38912
    ds_read_b64_tr_b16 v[52:53], v8 offset:39424
    v_fma_f32 v47, v47, v22, v23
    v_fma_f32 v48, v48, v22, v23
    v_fma_f32 v49, v49, v22, v23
    v_cvt_pk_bf16_f32 v164, v42, v43
    v_cvt_pk_bf16_f32 v165, v44, v45
    v_cvt_pk_bf16_f32 v166, v46, v47
    v_cvt_pk_bf16_f32 v167, v48, v49
    ds_write_b128 v16, v[164:167] offset:17408
    s_setprio 0
    s_waitcnt lgkmcnt(8)
    v_mfma_f32_32x32x16_bf16 v[96:111], v[58:61], v[156:159], v[96:111]
    ds_read_b64_tr_b16 v[54:55], v5 offset:2048
    ds_read_b64_tr_b16 v[56:57], v5 offset:2560
    s_waitcnt lgkmcnt(2)
    s_barrier
    ds_read_b128 v[184:187], v21 offset:16384
    ds_read_b128 v[188:191], v21 offset:17408
    s_setprio 3
    v_mfma_f32_32x32x16_bf16 v[72:87], v[62:65], v[160:163], v[72:87]
    ds_read_b64_tr_b16 v[58:59], v7 offset:0
    ds_read_b64_tr_b16 v[60:61], v7 offset:512
    s_add_u32 m0, s36, 0
    s_add_u32 s38, s31, 3538944
    buffer_load_dwordx4 v14, s[8:11], s38 offen lds
    v_lshlrev_b32 v34, 16, v168
    v_and_b32 v35, s44, v168
    v_lshlrev_b32 v36, 16, v169
    v_and_b32 v37, s44, v169
    v_lshlrev_b32 v38, 16, v170
    v_and_b32 v39, s44, v170
    v_lshlrev_b32 v40, 16, v171
    v_and_b32 v41, s44, v171
    v_mfma_f32_32x32x16_bf16 v[96:111], v[66:69], v[160:163], v[96:111]
    ds_read_b64_tr_b16 v[62:63], v7 offset:2048
    ds_read_b64_tr_b16 v[64:65], v7 offset:2560
    v_fma_f32 v34, v34, v22, v23
    v_fma_f32 v35, v35, v22, v23
    v_fma_f32 v36, v36, v22, v23
    v_fma_f32 v37, v37, v22, v23
    v_fma_f32 v38, v38, v22, v23
    v_fma_f32 v39, v39, v22, v23
    s_cmp_eq_u32 s25, 0
    s_cbranch_scc0 K1_X_16
    s_add_u32 m0, s37, 0
    s_add_u32 s38, s32, 3538944
    buffer_load_dwordx4 v14, s[8:11], s38 offen lds
K1_X_16:
    v_fma_f32 v40, v40, v22, v23
    v_fma_f32 v41, v41, v22, v23
    s_setprio 2
    v_mfma_f32_32x32x16_bf16 v[72:87], v[50:53], v[164:167], v[72:87]
    ds_read_b64_tr_b16 v[66:67], v8 offset:40960
    ds_read_b64_tr_b16 v[68:69], v8 offset:41472
    v_cvt_pk_bf16_f32 v168, v34, v35
    v_cvt_pk_bf16_f32 v169, v36, v37
    v_cvt_pk_bf16_f32 v170, v38, v39
    v_cvt_pk_bf16_f32 v171, v40, v41
    ds_write_b128 v16, v[168:171] offset:0
    v_lshlrev_b32 v42, 16, v172
    v_and_b32 v43, s44, v172
    v_lshlrev_b32 v44, 16, v173
    v_and_b32 v45, s44, v173
    s_setprio 1
    s_waitcnt lgkmcnt(9)
    v_mfma_f32_32x32x16_bf16 v[96:111], v[54:57], v[164:167], v[96:111]
    ds_read_b64_tr_b16 v[50:51], v5 offset:4096
    ds_read_b64_tr_b16 v[52:53], v5 offset:4608
    v_lshlrev_b32 v46, 16, v174
    v_and_b32 v47, s44, v174
    v_lshlrev_b32 v48, 16, v175
    v_and_b32 v49, s44, v175
    v_fma_f32 v42, v42, v22, v23
    v_fma_f32 v43, v43, v22, v23
    v_fma_f32 v44, v44, v22, v23
    v_fma_f32 v45, v45, v22, v23
    v_fma_f32 v46, v46, v22, v23
    s_waitcnt lgkmcnt(7)
    v_mfma_f32_32x32x16_bf16 v[96:111], v[58:61], v[184:187], v[96:111]
    ds_read_b64_tr_b16 v[54:55], v8 offset:43008
    ds_read_b64_tr_b16 v[56:57], v8 offset:43520
    v_fma_f32 v47, v47, v22, v23
    v_fma_f32 v48, v48, v22, v23
    v_fma_f32 v49, v49, v22, v23
    v_cvt_pk_bf16_f32 v172, v42, v43
    v_cvt_pk_bf16_f32 v173, v44, v45
    v_cvt_pk_bf16_f32 v174, v46, v47
    v_cvt_pk_bf16_f32 v175, v48, v49
    ds_write_b128 v16, v[172:175] offset:1024
    s_setprio 0
    s_waitcnt lgkmcnt(8)
    v_mfma_f32_32x32x16_bf16 v[96:111], v[62:65], v[188:191], v[96:111]
    ds_read_b64_tr_b16 v[58:59], v5 offset:6144
    ds_read_b64_tr_b16 v[60:61], v5 offset:6656
    s_waitcnt lgkmcnt(2)
    s_barrier
    ds_read_b128 v[192:195], v21 offset:0
    ds_read_b128 v[196:199], v21 offset:1024
    s_setprio 3
    v_mfma_f32_32x32x16_bf16 v[72:87], v[66:69], v[168:171], v[72:87]
    ds_read_b64_tr_b16 v[62:63], v7 offset:4096
    ds_read_b64_tr_b16 v[64:65], v7 offset:4608
    v_lshlrev_b32 v34, 16, v176
    v_and_b32 v35, s44, v176
    v_lshlrev_b32 v36, 16, v177
    v_and_b32 v37, s44, v177
    v_lshlrev_b32 v38, 16, v178
    v_and_b32 v39, s44, v178
    v_lshlrev_b32 v40, 16, v179
    v_and_b32 v41, s44, v179
    v_fma_f32 v34, v34, v22, v23
    v_mfma_f32_32x32x16_bf16 v[96:111], v[50:53], v[168:171], v[96:111]
    ds_read_b64_tr_b16 v[66:67], v7 offset:6144
    ds_read_b64_tr_b16 v[68:69], v7 offset:6656
    v_fma_f32 v35, v35, v22, v23
    v_fma_f32 v36, v36, v22, v23
    v_fma_f32 v37, v37, v22, v23
    v_fma_f32 v38, v38, v22, v23
    v_fma_f32 v39, v39, v22, v23
    v_fma_f32 v40, v40, v22, v23
    v_fma_f32 v41, v41, v22, v23
    v_cvt_pk_bf16_f32 v176, v34, v35
    v_cvt_pk_bf16_f32 v177, v36, v37
    s_setprio 2
    v_mfma_f32_32x32x16_bf16 v[72:87], v[54:57], v[172:175], v[72:87]
    ds_read_b64_tr_b16 v[50:51], v8 offset:45056
    ds_read_b64_tr_b16 v[52:53], v8 offset:45568
    v_cvt_pk_bf16_f32 v178, v38, v39
    v_cvt_pk_bf16_f32 v179, v40, v41
    ds_write_b128 v16, v[176:179] offset:16384
    v_lshlrev_b32 v42, 16, v180
    v_and_b32 v43, s44, v180
    v_lshlrev_b32 v44, 16, v181
    v_and_b32 v45, s44, v181
    v_lshlrev_b32 v46, 16, v182
    s_setprio 1
    s_waitcnt lgkmcnt(9)
    v_mfma_f32_32x32x16_bf16 v[96:111], v[58:61], v[172:175], v[96:111]
    ds_read_b64_tr_b16 v[54:55], v5 offset:8192
    ds_read_b64_tr_b16 v[56:57], v5 offset:8704
    v_and_b32 v47, s44, v182
    v_lshlrev_b32 v48, 16, v183
    v_and_b32 v49, s44, v183
    v_fma_f32 v42, v42, v22, v23
    v_fma_f32 v43, v43, v22, v23
    v_fma_f32 v44, v44, v22, v23
    v_fma_f32 v45, v45, v22, v23
    v_fma_f32 v46, v46, v22, v23
    s_waitcnt lgkmcnt(7)
    v_mfma_f32_32x32x16_bf16 v[96:111], v[62:65], v[192:195], v[96:111]
    ds_read_b64_tr_b16 v[58:59], v8 offset:47104
    ds_read_b64_tr_b16 v[60:61], v8 offset:47616
    v_fma_f32 v47, v47, v22, v23
    v_fma_f32 v48, v48, v22, v23
    v_fma_f32 v49, v49, v22, v23
    v_cvt_pk_bf16_f32 v180, v42, v43
    v_cvt_pk_bf16_f32 v181, v44, v45
    v_cvt_pk_bf16_f32 v182, v46, v47
    v_cvt_pk_bf16_f32 v183, v48, v49
    ds_write_b128 v16, v[180:183] offset:17408
    s_setprio 0
    s_waitcnt lgkmcnt(8)
    v_mfma_f32_32x32x16_bf16 v[96:111], v[66:69], v[196:199], v[96:111]
    ds_read_b64_tr_b16 v[62:63], v5 offset:10240
    ds_read_b64_tr_b16 v[64:65], v5 offset:10752
    s_waitcnt vmcnt(0) lgkmcnt(2)
    s_barrier
    ds_read_b128 v[200:203], v21 offset:16384
    ds_read_b128 v[204:207], v21 offset:17408
    s_setprio 3
    v_mfma_f32_32x32x16_bf16 v[72:87], v[50:53], v[176:179], v[72:87]
    ds_read_b64_tr_b16 v[66:67], v7 offset:8192
    ds_read_b64_tr_b16 v[68:69], v7 offset:8704
    v_lshlrev_b32 v34, 16, v208
    v_and_b32 v35, s44, v208
    v_lshlrev_b32 v36, 16, v209
    v_and_b32 v37, s44, v209
    v_lshlrev_b32 v38, 16, v210
    v_and_b32 v39, s44, v210
    v_lshlrev_b32 v40, 16, v211
    v_and_b32 v41, s44, v211
    v_fma_f32 v34, v34, v22, v23
    v_mfma_f32_32x32x16_bf16 v[96:111], v[54:57], v[176:179], v[96:111]
    ds_read_b64_tr_b16 v[50:51], v7 offset:10240
    ds_read_b64_tr_b16 v[52:53], v7 offset:10752
    v_fma_f32 v35, v35, v22, v23
    v_fma_f32 v36, v36, v22, v23
    v_fma_f32 v37, v37, v22, v23
    v_fma_f32 v38, v38, v22, v23
    v_fma_f32 v39, v39, v22, v23
    v_fma_f32 v40, v40, v22, v23
    v_fma_f32 v41, v41, v22, v23
    v_cvt_pk_bf16_f32 v208, v34, v35
    v_cvt_pk_bf16_f32 v209, v36, v37
    s_setprio 2
    v_mfma_f32_32x32x16_bf16 v[72:87], v[58:61], v[180:183], v[72:87]
    ds_read_b64_tr_b16 v[54:55], v8 offset:0
    ds_read_b64_tr_b16 v[56:57], v8 offset:512
    v_cvt_pk_bf16_f32 v210, v38, v39
    v_cvt_pk_bf16_f32 v211, v40, v41
    ds_write_b128 v16, v[208:211] offset:0
    v_lshlrev_b32 v42, 16, v212
    v_and_b32 v43, s44, v212
    v_lshlrev_b32 v44, 16, v213
    v_and_b32 v45, s44, v213
    v_lshlrev_b32 v46, 16, v214
    s_setprio 1
    s_waitcnt lgkmcnt(9)
    v_mfma_f32_32x32x16_bf16 v[96:111], v[62:65], v[180:183], v[96:111]
    ds_read_b64_tr_b16 v[58:59], v5 offset:24576
    ds_read_b64_tr_b16 v[60:61], v5 offset:25088
    v_and_b32 v47, s44, v214
    v_lshlrev_b32 v48, 16, v215
    v_and_b32 v49, s44, v215
    v_fma_f32 v42, v42, v22, v23
    v_fma_f32 v43, v43, v22, v23
    v_fma_f32 v44, v44, v22, v23
    v_fma_f32 v45, v45, v22, v23
    v_fma_f32 v46, v46, v22, v23
    s_waitcnt lgkmcnt(7)
    v_mfma_f32_32x32x16_bf16 v[96:111], v[66:69], v[200:203], v[96:111]
    ds_read_b64_tr_b16 v[62:63], v8 offset:2048
    ds_read_b64_tr_b16 v[64:65], v8 offset:2560
    v_fma_f32 v47, v47, v22, v23
    v_fma_f32 v48, v48, v22, v23
    v_fma_f32 v49, v49, v22, v23
    v_cvt_pk_bf16_f32 v212, v42, v43
    v_cvt_pk_bf16_f32 v213, v44, v45
    v_cvt_pk_bf16_f32 v214, v46, v47
    v_cvt_pk_bf16_f32 v215, v48, v49
    ds_write_b128 v16, v[212:215] offset:1024
    s_setprio 0
    s_waitcnt lgkmcnt(8)
    v_mfma_f32_32x32x16_bf16 v[96:111], v[50:53], v[204:207], v[96:111]
    ds_read_b64_tr_b16 v[66:67], v5 offset:26624
    ds_read_b64_tr_b16 v[68:69], v5 offset:27136
    s_waitcnt lgkmcnt(2)
    s_barrier
    ds_read_b128 v[232:235], v21 offset:0
    ds_read_b128 v[236:239], v21 offset:1024
    s_setprio 3
    v_mfma_f32_32x32x16_bf16 v[72:87], v[54:57], v[208:211], v[72:87]
    ds_read_b64_tr_b16 v[50:51], v7 offset:24576
    ds_read_b64_tr_b16 v[52:53], v7 offset:25088
    s_add_u32 m0, s36, 24576
    s_add_u32 s38, s29, 128
    buffer_load_dwordx4 v13, s[8:11], s38 offen lds
    v_lshlrev_b32 v34, 16, v216
    v_and_b32 v35, s44, v216
    v_lshlrev_b32 v36, 16, v217
    v_and_b32 v37, s44, v217
    v_lshlrev_b32 v38, 16, v218
    v_and_b32 v39, s44, v218
    s_add_u32 m0, s36, 36864
    s_add_u32 s38, s29, 884864
    buffer_load_dwordx4 v13, s[8:11], s38 offen lds
    v_lshlrev_b32 v40, 16, v219
    v_and_b32 v41, s44, v219
    v_mfma_f32_32x32x16_bf16 v[96:111], v[58:61], v[208:211], v[96:111]
    ds_read_b64_tr_b16 v[54:55], v7 offset:26624
    ds_read_b64_tr_b16 v[56:57], v7 offset:27136
    v_fma_f32 v34, v34, v22, v23
    v_fma_f32 v35, v35, v22, v23
    v_fma_f32 v36, v36, v22, v23
    v_fma_f32 v37, v37, v22, v23
    s_add_u32 m0, s50, 24576
    s_add_u32 s38, s48, 128
    buffer_load_dwordx4 v13, s[8:11], s38 offen lds
    v_fma_f32 v38, v38, v22, v23
    v_fma_f32 v39, v39, v22, v23
    v_fma_f32 v40, v40, v22, v23
    v_fma_f32 v41, v41, v22, v23
    v_cvt_pk_bf16_f32 v216, v34, v35
    s_setprio 2
    v_mfma_f32_32x32x16_bf16 v[72:87], v[62:65], v[212:215], v[72:87]
    ds_read_b64_tr_b16 v[58:59], v8 offset:4096
    ds_read_b64_tr_b16 v[60:61], v8 offset:4608
    v_cvt_pk_bf16_f32 v217, v36, v37
    s_add_u32 m0, s36, 49152
    s_add_u32 s38, s29, 1769600
    buffer_load_dwordx4 v13, s[8:11], s38 offen lds
    v_cvt_pk_bf16_f32 v218, v38, v39
    v_cvt_pk_bf16_f32 v219, v40, v41
    ds_write_b128 v16, v[216:219] offset:16384
    v_lshlrev_b32 v42, 16, v220
    v_and_b32 v43, s44, v220
    v_lshlrev_b32 v44, 16, v221
    s_add_u32 m0, s36, 61440
    s_add_u32 s38, s29, 2654336
    buffer_load_dwordx4 v13, s[8:11], s38 offen lds
    v_and_b32 v45, s44, v221
    s_setprio 1
    s_waitcnt lgkmcnt(9)
    v_mfma_f32_32x32x16_bf16 v[96:111], v[66:69], v[212:215], v[96:111]
    ds_read_b64_tr_b16 v[62:63], v5 offset:28672
    ds_read_b64_tr_b16 v[64:65], v5 offset:29184
    v_lshlrev_b32 v46, 16, v222
    v_and_b32 v47, s44, v222
    v_lshlrev_b32 v48, 16, v223
    v_and_b32 v49, s44, v223
    v_fma_f32 v42, v42, v22, v23
    s_add_u32 m0, s50, 49152
    s_add_u32 s38, s48, 1769600
    buffer_load_dwordx4 v13, s[8:11], s38 offen lds
    v_fma_f32 v43, v43, v22, v23
    v_fma_f32 v44, v44, v22, v23
    v_fma_f32 v45, v45, v22, v23
    s_waitcnt lgkmcnt(7)
    v_mfma_f32_32x32x16_bf16 v[96:111], v[50:53], v[232:235], v[96:111]
    ds_read_b64_tr_b16 v[66:67], v8 offset:6144
    ds_read_b64_tr_b16 v[68:69], v8 offset:6656
    v_fma_f32 v46, v46, v22, v23
    v_fma_f32 v47, v47, v22, v23
    v_fma_f32 v48, v48, v22, v23
    v_fma_f32 v49, v49, v22, v23
    v_cvt_pk_bf16_f32 v220, v42, v43
    v_cvt_pk_bf16_f32 v221, v44, v45
    v_cvt_pk_bf16_f32 v222, v46, v47
    v_cvt_pk_bf16_f32 v223, v48, v49
    ds_write_b128 v16, v[220:223] offset:17408
    s_setprio 0
    s_waitcnt lgkmcnt(8)
    v_mfma_f32_32x32x16_bf16 v[96:111], v[54:57], v[236:239], v[96:111]
    ds_read_b64_tr_b16 v[50:51], v5 offset:30720
    ds_read_b64_tr_b16 v[52:53], v5 offset:31232
    s_waitcnt lgkmcnt(2)
    s_barrier
    ds_read_b128 v[240:243], v21 offset:16384
    ds_read_b128 v[244:247], v21 offset:17408
    s_setprio 3
    v_mfma_f32_32x32x16_bf16 v[72:87], v[58:61], v[216:219], v[72:87]
    ds_read_b64_tr_b16 v[54:55], v7 offset:28672
    ds_read_b64_tr_b16 v[56:57], v7 offset:29184
    v_lshlrev_b32 v34, 16, v224
    v_and_b32 v35, s44, v224
    v_lshlrev_b32 v36, 16, v225
    v_and_b32 v37, s44, v225
    v_lshlrev_b32 v38, 16, v226
    v_and_b32 v39, s44, v226
    v_lshlrev_b32 v40, 16, v227
    v_and_b32 v41, s44, v227
    v_fma_f32 v34, v34, v22, v23
    v_mfma_f32_32x32x16_bf16 v[96:111], v[62:65], v[216:219], v[96:111]
    ds_read_b64_tr_b16 v[58:59], v7 offset:30720
    ds_read_b64_tr_b16 v[60:61], v7 offset:31232
    v_fma_f32 v35, v35, v22, v23
    v_fma_f32 v36, v36, v22, v23
    v_fma_f32 v37, v37, v22, v23
    v_fma_f32 v38, v38, v22, v23
    v_fma_f32 v39, v39, v22, v23
    v_fma_f32 v40, v40, v22, v23
    v_fma_f32 v41, v41, v22, v23
    v_cvt_pk_bf16_f32 v224, v34, v35
    v_cvt_pk_bf16_f32 v225, v36, v37
    s_setprio 2
    v_mfma_f32_32x32x16_bf16 v[72:87], v[66:69], v[220:223], v[72:87]
    ds_read_b64_tr_b16 v[62:63], v8 offset:8192
    ds_read_b64_tr_b16 v[64:65], v8 offset:8704
    v_cvt_pk_bf16_f32 v226, v38, v39
    v_cvt_pk_bf16_f32 v227, v40, v41
    ds_write_b128 v16, v[224:227] offset:0
    v_lshlrev_b32 v42, 16, v228
    v_and_b32 v43, s44, v228
    v_lshlrev_b32 v44, 16, v229
    v_and_b32 v45, s44, v229
    v_lshlrev_b32 v46, 16, v230
    s_setprio 1
    s_waitcnt lgkmcnt(9)
    v_mfma_f32_32x32x16_bf16 v[96:111], v[50:53], v[220:223], v[96:111]
    ds_read_b64_tr_b16 v[66:67], v5 offset:32768
    ds_read_b64_tr_b16 v[68:69], v5 offset:33280
    v_and_b32 v47, s44, v230
    v_lshlrev_b32 v48, 16, v231
    v_and_b32 v49, s44, v231
    v_fma_f32 v42, v42, v22, v23
    v_fma_f32 v43, v43, v22, v23
    v_fma_f32 v44, v44, v22, v23
    v_fma_f32 v45, v45, v22, v23
    v_fma_f32 v46, v46, v22, v23
    s_waitcnt lgkmcnt(7)
    v_mfma_f32_32x32x16_bf16 v[96:111], v[54:57], v[240:243], v[96:111]
    ds_read_b64_tr_b16 v[50:51], v8 offset:10240
    ds_read_b64_tr_b16 v[52:53], v8 offset:10752
    v_fma_f32 v47, v47, v22, v23
    v_fma_f32 v48, v48, v22, v23
    v_fma_f32 v49, v49, v22, v23
    v_cvt_pk_bf16_f32 v228, v42, v43
    v_cvt_pk_bf16_f32 v229, v44, v45
    v_cvt_pk_bf16_f32 v230, v46, v47
    v_cvt_pk_bf16_f32 v231, v48, v49
    ds_write_b128 v16, v[228:231] offset:1024
    s_setprio 0
    s_waitcnt lgkmcnt(8)
    v_mfma_f32_32x32x16_bf16 v[96:111], v[58:61], v[244:247], v[96:111]
    ds_read_b64_tr_b16 v[54:55], v5 offset:34816
    ds_read_b64_tr_b16 v[56:57], v5 offset:35328
    s_waitcnt vmcnt(3) lgkmcnt(2)
    s_barrier
    ds_read_b128 v[248:251], v21 offset:0
    ds_read_b128 v[252:255], v21 offset:1024
    s_setprio 3
    v_mfma_f32_32x32x16_bf16 v[72:87], v[62:65], v[224:227], v[72:87]
    ds_read_b64_tr_b16 v[58:59], v7 offset:32768
    ds_read_b64_tr_b16 v[60:61], v7 offset:33280
    s_cmp_lt_u32 s27, 9
    s_cbranch_scc0 K1_XJ_17
    s_lshl_b32 s38, s27, 6
    s_and_b32 s45, s24, 6
    s_lshl_b32 s45, s45, 3
    s_add_u32 s38, s38, s45
    s_lshl_b32 s38, s38, 12
    s_lshl_b32 s45, s28, 8
    s_add_u32 s38, s38, s45
    s_and_b32 s45, s24, 1
    s_lshl_b32 s46, s45, 7
    s_add_u32 s38, s38, s46
    s_add_u32 s38, s38, 40108032
    s_lshl_b32 s45, s45, 9
    s_add_u32 s45, s45, 157696
    v_lshlrev_b32 v89, 5, v2
    v_add_u32 v89, s45, v89
    s_add_u32 s46, s41, 139264
    v_lshlrev_b32 v88, 4, v2
    v_lshl_add_u32 v88, v3, 7, v88
    v_add_u32 v88, s46, v88
    ds_read_b128 v[34:37], v89 offset:0
    ds_read_b128 v[38:41], v89 offset:16
    ds_read_b128 v[42:45], v89 offset:128
    ds_read_b128 v[46:49], v89 offset:144
    s_waitcnt lgkmcnt(0)
    v_lshlrev_b32 v90, 16, v26
    v_and_b32 v91, s44, v26
    v_fma_f32 v90, v90, v34, v35
    v_fma_f32 v91, v91, v42, v43
    v_cvt_pk_bf16_f32 v26, v90, v91
    v_lshlrev_b32 v90, 16, v27
    v_and_b32 v91, s44, v27
    v_fma_f32 v90, v90, v36, v37
    v_fma_f32 v91, v91, v44, v45
    v_cvt_pk_bf16_f32 v27, v90, v91
    v_lshlrev_b32 v90, 16, v28
    v_and_b32 v91, s44, v28
    v_fma_f32 v90, v90, v38, v39
    v_fma_f32 v91, v91, v46, v47
    v_cvt_pk_bf16_f32 v28, v90, v91
    v_lshlrev_b32 v90, 16, v29
    v_and_b32 v91, s44, v29
    v_fma_f32 v90, v90, v40, v41
    v_fma_f32 v91, v91, v48, v49
    v_cvt_pk_bf16_f32 v29, v90, v91
    ds_write_b128 v88, v[26:29] offset:0
    ds_read_b128 v[34:37], v89 offset:256
    ds_read_b128 v[38:41], v89 offset:272
    ds_read_b128 v[42:45], v89 offset:384
    ds_read_b128 v[46:49], v89 offset:400
    s_waitcnt lgkmcnt(0)
    v_lshlrev_b32 v90, 16, v30
    v_and_b32 v91, s44, v30
    v_fma_f32 v90, v90, v34, v35
    v_fma_f32 v91, v91, v42, v43
    v_cvt_pk_bf16_f32 v30, v90, v91
    v_lshlrev_b32 v90, 16, v31
    v_and_b32 v91, s44, v31
    v_fma_f32 v90, v90, v36, v37
    v_fma_f32 v91, v91, v44, v45
    v_cvt_pk_bf16_f32 v31, v90, v91
    v_lshlrev_b32 v90, 16, v32
    v_and_b32 v91, s44, v32
    v_fma_f32 v90, v90, v38, v39
    v_fma_f32 v91, v91, v46, v47
    v_cvt_pk_bf16_f32 v32, v90, v91
    v_lshlrev_b32 v90, 16, v33
    v_and_b32 v91, s44, v33
    v_fma_f32 v90, v90, v40, v41
    v_fma_f32 v91, v91, v48, v49
    v_cvt_pk_bf16_f32 v33, v90, v91
    ds_write_b128 v88, v[30:33] offset:64
    v_lshlrev_b32 v88, 4, v1
    v_add_u32 v88, s46, v88
    v_lshrrev_b32 v89, 3, v1
    v_lshlrev_b32 v89, 12, v89
    v_and_b32 v90, 7, v1
    v_lshl_add_u32 v89, v90, 4, v89
    s_waitcnt lgkmcnt(0)
    ds_read_b128 v[34:37], v88
    ds_read_b128 v[38:41], v88 offset:1024
    s_add_u32 s45, s38, 32768
    s_waitcnt lgkmcnt(0)
    buffer_store_dwordx4 v[34:37], v89, s[16:19], s38 offen sc1
    buffer_store_dwordx4 v[38:41], v89, s[16:19], s45 offen sc1
    s_nop 1
K1_XJ_17:
    v_mfma_f32_32x32x16_bf16 v[96:111], v[66:69], v[224:227], v[96:111]
    ds_read_b64_tr_b16 v[62:63], v7 offset:34816
    ds_read_b64_tr_b16 v[64:65], v7 offset:35328
    s_setprio 2
    v_mfma_f32_32x32x16_bf16 v[72:87], v[50:53], v[228:231], v[72:87]
    ds_read_b64_tr_b16 v[66:67], v4 offset:24576
    ds_read_b64_tr_b16 v[68:69], v4 offset:25088
    s_setprio 1
    s_waitcnt lgkmcnt(8)
    v_mfma_f32_32x32x16_bf16 v[96:111], v[54:57], v[228:231], v[96:111]
    ds_read_b64_tr_b16 v[50:51], v4 offset:26624
    ds_read_b64_tr_b16 v[52:53], v4 offset:27136
    s_waitcnt lgkmcnt(6)
    v_mfma_f32_32x32x16_bf16 v[96:111], v[58:61], v[248:251], v[96:111]
    ds_read_b64_tr_b16 v[54:55], v4 offset:28672
    ds_read_b64_tr_b16 v[56:57], v4 offset:29184
    s_setprio 0
    s_waitcnt lgkmcnt(6)
    v_mfma_f32_32x32x16_bf16 v[96:111], v[62:65], v[252:255], v[96:111]
    ds_read_b64_tr_b16 v[58:59], v4 offset:30720
    ds_read_b64_tr_b16 v[60:61], v4 offset:31232
    s_waitcnt vmcnt(0)
    s_barrier
    s_nop 7
    ds_write_b128 v16, v[72:75] offset:24576
    ds_write_b128 v16, v[76:79] offset:25600
    ds_write_b128 v16, v[80:83] offset:40960
    ds_write_b128 v16, v[84:87] offset:41984
    ds_read_b128 v[72:75], v18 offset:384
    ds_read_b128 v[76:79], v18 offset:416
    ds_read_b128 v[80:83], v18 offset:448
    ds_read_b128 v[84:87], v18 offset:480
    s_setprio 3
    s_waitcnt lgkmcnt(0)
    v_mfma_f32_32x32x16_bf16 v[72:87], v[66:69], v[112:115], v[72:87]
    ds_read_b64_tr_b16 v[62:63], v4 offset:32768
    ds_read_b64_tr_b16 v[64:65], v4 offset:33280
    s_add_u32 m0, s36, 0
    s_add_u32 s38, s29, 256
    buffer_load_dwordx4 v13, s[8:11], s38 offen lds
    v_fmaak_f32 v34, v96, v96, 0x409d30fc
    v_fmaak_f32 v35, v97, v97, 0x409d30fc
    v_fmaak_f32 v36, v98, v98, 0x409d30fc
    v_mfma_f32_32x32x16_bf16 v[72:87], v[50:53], v[116:119], v[72:87]
    ds_read_b64_tr_b16 v[66:67], v4 offset:34816
    ds_read_b64_tr_b16 v[68:69], v4 offset:35328
    v_fmaak_f32 v37, v99, v99, 0x409d30fc
    v_mul_f32 v34, v96, v34
    s_add_u32 m0, s36, 12288
    s_add_u32 s38, s29, 884992
    buffer_load_dwordx4 v13, s[8:11], s38 offen lds
    v_mul_f32 v35, v97, v35
    v_mfma_f32_32x32x16_bf16 v[72:87], v[54:57], v[120:123], v[72:87]
    ds_read_b64_tr_b16 v[50:51], v6 offset:24576
    ds_read_b64_tr_b16 v[52:53], v6 offset:25088
    v_mul_f32 v36, v98, v36
    v_mul_f32 v37, v99, v37
    v_exp_f32 v34, -v34
    v_exp_f32 v35, -v35
    s_setprio 2
    v_mfma_f32_32x32x16_bf16 v[72:87], v[58:61], v[124:127], v[72:87]
    ds_read_b64_tr_b16 v[54:55], v6 offset:26624
    ds_read_b64_tr_b16 v[56:57], v6 offset:27136
    s_add_u32 m0, s50, 0
    s_add_u32 s38, s48, 256
    buffer_load_dwordx4 v13, s[8:11], s38 offen lds
    v_exp_f32 v36, -v36
    v_exp_f32 v37, -v37
    v_fma_f32 v34, v34, s47, s47
    s_waitcnt lgkmcnt(6)
    v_mfma_f32_32x32x16_bf16 v[72:87], v[62:65], v[128:131], v[72:87]
    ds_read_b64_tr_b16 v[58:59], v6 offset:28672
    ds_read_b64_tr_b16 v[60:61], v6 offset:29184
    v_fma_f32 v35, v35, s47, s47
    v_fma_f32 v36, v36, s47, s47
    s_add_u32 m0, s36, 73728
    s_add_u32 s38, s29, 3539072
    buffer_load_dwordx4 v13, s[8:11], s38 offen lds
    v_fma_f32 v37, v37, s47, s47
    s_waitcnt lgkmcnt(6)
    v_mfma_f32_32x32x16_bf16 v[72:87], v[66:69], v[132:135], v[72:87]
    ds_read_b64_tr_b16 v[62:63], v6 offset:30720
    ds_read_b64_tr_b16 v[64:65], v6 offset:31232
    v_rcp_f32 v34, v34
    v_rcp_f32 v35, v35
    v_rcp_f32 v36, v36
    v_rcp_f32 v37, v37
    s_setprio 1
    s_waitcnt lgkmcnt(6)
    v_mfma_f32_32x32x16_bf16 v[72:87], v[50:53], v[136:139], v[72:87]
    ds_read_b64_tr_b16 v[66:67], v6 offset:32768
    ds_read_b64_tr_b16 v[68:69], v6 offset:33280
    s_add_u32 m0, s36, 86016
    s_add_u32 s38, s29, 4423808
    buffer_load_dwordx4 v13, s[8:11], s38 offen lds
    v_mul_f32 v34, v96, v34
    v_mul_f32 v35, v97, v35
    v_mul_f32 v36, v98, v36
    s_waitcnt lgkmcnt(6)
    v_mfma_f32_32x32x16_bf16 v[72:87], v[54:57], v[140:143], v[72:87]
    ds_read_b64_tr_b16 v[50:51], v6 offset:34816
    ds_read_b64_tr_b16 v[52:53], v6 offset:35328
    v_mul_f32 v37, v99, v37
    v_cvt_pk_bf16_f32 v42, v34, v35
    s_add_u32 m0, s50, 73728
    s_add_u32 s38, s48, 3539072
    buffer_load_dwordx4 v13, s[8:11], s38 offen lds
    v_cvt_pk_bf16_f32 v43, v36, v37
    s_waitcnt lgkmcnt(6)
    v_mfma_f32_32x32x16_bf16 v[72:87], v[58:61], v[144:147], v[72:87]
    ds_read_b64_tr_b16 v[54:55], v5 offset:0
    ds_read_b64_tr_b16 v[56:57], v5 offset:512
    v_fmaak_f32 v38, v100, v100, 0x409d30fc
    v_fmaak_f32 v39, v101, v101, 0x409d30fc
    v_fmaak_f32 v40, v102, v102, 0x409d30fc
    v_fmaak_f32 v41, v103, v103, 0x409d30fc
    s_setprio 0
    s_waitcnt lgkmcnt(6)
    v_mfma_f32_32x32x16_bf16 v[72:87], v[62:65], v[148:151], v[72:87]
    ds_read_b64_tr_b16 v[58:59], v5 offset:2048
    ds_read_b64_tr_b16 v[60:61], v5 offset:2560
    v_mul_f32 v38, v100, v38
    v_mul_f32 v39, v101, v39
    v_mul_f32 v40, v102, v40
    s_waitcnt lgkmcnt(6)
    v_mfma_f32_32x32x16_bf16 v[72:87], v[66:69], v[152:155], v[72:87]
    ds_read_b64_tr_b16 v[62:63], v5 offset:4096
    ds_read_b64_tr_b16 v[64:65], v5 offset:4608
    v_mul_f32 v41, v103, v41
    v_exp_f32 v38, -v38
    v_exp_f32 v39, -v39
    s_waitcnt lgkmcnt(6)
    v_mfma_f32_32x32x16_bf16 v[72:87], v[50:53], v[156:159], v[72:87]
    ds_read_b64_tr_b16 v[66:67], v5 offset:6144
    ds_read_b64_tr_b16 v[68:69], v5 offset:6656
    s_waitcnt vmcnt(0)
    s_barrier
    s_setprio 3
    s_waitcnt lgkmcnt(6)
    v_mfma_f32_32x32x16_bf16 v[72:87], v[54:57], v[160:163], v[72:87]
    ds_read_b64_tr_b16 v[50:51], v5 offset:8192
    ds_read_b64_tr_b16 v[52:53], v5 offset:8704
    s_add_u32 m0, s36, 24576
    s_add_u32 s38, s29, 1769728
    buffer_load_dwordx4 v13, s[8:11], s38 offen lds
    ds_read_b128 v[88:91], v24 offset:24576
    ds_read_b128 v[92:95], v24 offset:25600
    ds_read_b128 v[26:29], v24 offset:32768
    s_waitcnt lgkmcnt(9)
    v_mfma_f32_32x32x16_bf16 v[72:87], v[58:61], v[164:167], v[72:87]
    ds_read_b64_tr_b16 v[54:55], v5 offset:10240
    ds_read_b64_tr_b16 v[56:57], v5 offset:10752
    ds_read_b128 v[30:33], v24 offset:33792
    v_exp_f32 v40, -v40
    v_exp_f32 v41, -v41
    v_fma_f32 v38, v38, s47, s47
    s_waitcnt lgkmcnt(10)
    v_mfma_f32_32x32x16_bf16 v[72:87], v[62:65], v[168:171], v[72:87]
    ds_read_b64_tr_b16 v[58:59], v7 offset:0
    ds_read_b64_tr_b16 v[60:61], v7 offset:512
    v_fma_f32 v39, v39, s47, s47
    v_fma_f32 v40, v40, s47, s47
    v_fma_f32 v41, v41, s47, s47
    s_add_u32 m0, s36, 36864
    s_add_u32 s38, s29, 2654464
    buffer_load_dwordx4 v13, s[8:11], s38 offen lds
    s_setprio 2
    s_waitcnt lgkmcnt(10)
    v_mfma_f32_32x32x16_bf16 v[72:87], v[66:69], v[172:175], v[72:87]
    ds_read_b64_tr_b16 v[62:63], v7 offset:2048
    ds_read_b64_tr_b16 v[64:65], v7 offset:2560
    v_rcp_f32 v38, v38
    v_rcp_f32 v39, v39
    v_rcp_f32 v40, v40
    v_rcp_f32 v41, v41
    s_waitcnt lgkmcnt(10)
    v_mfma_f32_32x32x16_bf16 v[72:87], v[50:53], v[176:179], v[72:87]
    ds_read_b64_tr_b16 v[66:67], v7 offset:4096
    ds_read_b64_tr_b16 v[68:69], v7 offset:4608
    v_mul_f32 v38, v100, v38
    v_mul_f32 v39, v101, v39
    v_mul_f32 v40, v102, v40
    v_mul_f32 v41, v103, v41
    s_waitcnt lgkmcnt(7)
    v_mfma_f32_32x32x16_bf16 v[72:87], v[54:57], v[180:183], v[72:87]
    ds_read_b64_tr_b16 v[50:51], v7 offset:6144
    ds_read_b64_tr_b16 v[52:53], v7 offset:6656
    v_cvt_pk_bf16_f32 v44, v38, v39
    v_cvt_pk_bf16_f32 v45, v40, v41
    s_add_u32 m0, s50, 24576
    s_add_u32 s38, s48, 1769728
    buffer_load_dwordx4 v13, s[8:11], s38 offen lds
    ds_write_b128 v16, v[42:45] offset:8192
    s_setprio 1
    s_waitcnt lgkmcnt(7)
    v_mfma_f32_32x32x16_bf16 v[72:87], v[58:61], v[184:187], v[72:87]
    ds_read_b64_tr_b16 v[54:55], v7 offset:8192
    ds_read_b64_tr_b16 v[56:57], v7 offset:8704
    v_fmaak_f32 v34, v104, v104, 0x409d30fc
    v_fmaak_f32 v35, v105, v105, 0x409d30fc
    v_fmaak_f32 v36, v106, v106, 0x409d30fc
    v_fmaak_f32 v37, v107, v107, 0x409d30fc
    s_waitcnt lgkmcnt(7)
    v_mfma_f32_32x32x16_bf16 v[72:87], v[62:65], v[188:191], v[72:87]
    ds_read_b64_tr_b16 v[58:59], v7 offset:10240
    ds_read_b64_tr_b16 v[60:61], v7 offset:10752
    v_mul_f32 v34, v104, v34
    v_mul_f32 v35, v105, v35
    v_mul_f32 v36, v106, v36
    v_mul_f32 v37, v107, v37
    s_waitcnt lgkmcnt(7)
    v_mfma_f32_32x32x16_bf16 v[72:87], v[66:69], v[192:195], v[72:87]
    ds_read_b64_tr_b16 v[62:63], v5 offset:24576
    ds_read_b64_tr_b16 v[64:65], v5 offset:25088
    v_exp_f32 v34, -v34
    v_exp_f32 v35, -v35
    v_exp_f32 v36, -v36
    v_exp_f32 v37, -v37
    s_setprio 0
    s_waitcnt lgkmcnt(7)
    v_mfma_f32_32x32x16_bf16 v[72:87], v[50:53], v[196:199], v[72:87]
    ds_read_b64_tr_b16 v[66:67], v5 offset:26624
    ds_read_b64_tr_b16 v[68:69], v5 offset:27136
    v_fma_f32 v34, v34, s47, s47
    v_fma_f32 v35, v35, s47, s47
    v_fma_f32 v36, v36, s47, s47
    v_fma_f32 v37, v37, s47, s47
    s_waitcnt lgkmcnt(6)
    v_mfma_f32_32x32x16_bf16 v[72:87], v[54:57], v[200:203], v[72:87]
    ds_read_b64_tr_b16 v[50:51], v5 offset:28672
    ds_read_b64_tr_b16 v[52:53], v5 offset:29184
    v_rcp_f32 v34, v34
    v_rcp_f32 v35, v35
    v_rcp_f32 v36, v36
    s_waitcnt lgkmcnt(6)
    v_mfma_f32_32x32x16_bf16 v[72:87], v[58:61], v[204:207], v[72:87]
    ds_read_b64_tr_b16 v[54:55], v5 offset:30720
    ds_read_b64_tr_b16 v[56:57], v5 offset:31232
    s_barrier
    s_setprio 3
    s_waitcnt lgkmcnt(6)
    v_mfma_f32_32x32x16_bf16 v[72:87], v[62:65], v[208:211], v[72:87]
    ds_read_b64_tr_b16 v[58:59], v5 offset:32768
    ds_read_b64_tr_b16 v[60:61], v5 offset:33280
    s_add_u32 m0, s36, 49152
    s_add_u32 s38, s29, 3539200
    buffer_load_dwordx4 v13, s[8:11], s38 offen lds
    v_rcp_f32 v37, v37
    v_mul_f32 v34, v104, v34
    v_mul_f32 v35, v105, v35
    s_waitcnt lgkmcnt(6)
    v_mfma_f32_32x32x16_bf16 v[72:87], v[66:69], v[212:215], v[72:87]
    ds_read_b64_tr_b16 v[62:63], v5 offset:34816
    ds_read_b64_tr_b16 v[64:65], v5 offset:35328
    v_mul_f32 v36, v106, v36
    v_mul_f32 v37, v107, v37
    v_cvt_pk_bf16_f32 v46, v34, v35
    v_cvt_pk_bf16_f32 v47, v36, v37
    s_waitcnt lgkmcnt(6)
    v_mfma_f32_32x32x16_bf16 v[72:87], v[50:53], v[216:219], v[72:87]
    ds_read_b64_tr_b16 v[66:67], v7 offset:24576
    ds_read_b64_tr_b16 v[68:69], v7 offset:25088
    v_fmaak_f32 v38, v108, v108, 0x409d30fc
    v_fmaak_f32 v39, v109, v109, 0x409d30fc
    s_add_u32 m0, s36, 61440
    s_add_u32 s38, s29, 4423936
    buffer_load_dwordx4 v13, s[8:11], s38 offen lds
    v_fmaak_f32 v40, v110, v110, 0x409d30fc
    s_setprio 2
    s_waitcnt lgkmcnt(6)
    v_mfma_f32_32x32x16_bf16 v[72:87], v[54:57], v[220:223], v[72:87]
    ds_read_b64_tr_b16 v[50:51], v7 offset:26624
    ds_read_b64_tr_b16 v[52:53], v7 offset:27136
    v_fmaak_f32 v41, v111, v111, 0x409d30fc
    v_mul_f32 v38, v108, v38
    v_mul_f32 v39, v109, v39
    v_mul_f32 v40, v110, v40
    s_waitcnt lgkmcnt(6)
    v_mfma_f32_32x32x16_bf16 v[72:87], v[58:61], v[224:227], v[72:87]
    ds_read_b64_tr_b16 v[54:55], v7 offset:28672
    ds_read_b64_tr_b16 v[56:57], v7 offset:29184
    v_mul_f32 v41, v111, v41
    v_exp_f32 v38, -v38
    v_exp_f32 v39, -v39
    v_exp_f32 v40, -v40
    s_waitcnt lgkmcnt(6)
    v_mfma_f32_32x32x16_bf16 v[72:87], v[62:65], v[228:231], v[72:87]
    ds_read_b64_tr_b16 v[58:59], v7 offset:30720
    ds_read_b64_tr_b16 v[60:61], v7 offset:31232
    s_add_u32 m0, s50, 49152
    s_add_u32 s38, s48, 3539200
    buffer_load_dwordx4 v13, s[8:11], s38 offen lds
    v_exp_f32 v41, -v41
    v_fma_f32 v38, v38, s47, s47
    v_fma_f32 v39, v39, s47, s47
    s_setprio 1
    s_waitcnt lgkmcnt(6)
    v_mfma_f32_32x32x16_bf16 v[72:87], v[66:69], v[232:235], v[72:87]
    ds_read_b64_tr_b16 v[62:63], v7 offset:32768
    ds_read_b64_tr_b16 v[64:65], v7 offset:33280
    v_fma_f32 v40, v40, s47, s47
    v_fma_f32 v41, v41, s47, s47
    v_rcp_f32 v38, v38
    v_rcp_f32 v39, v39
    s_waitcnt lgkmcnt(6)
    v_mfma_f32_32x32x16_bf16 v[72:87], v[50:53], v[236:239], v[72:87]
    ds_read_b64_tr_b16 v[66:67], v7 offset:34816
    ds_read_b64_tr_b16 v[68:69], v7 offset:35328
    v_rcp_f32 v40, v40
    v_rcp_f32 v41, v41
    v_mul_f32 v38, v108, v38
    v_mul_f32 v39, v109, v39
    s_waitcnt lgkmcnt(6)
    v_mfma_f32_32x32x16_bf16 v[72:87], v[54:57], v[240:243], v[72:87]
    ds_read_b64_tr_b16 v[50:51], v4 offset:0
    ds_read_b64_tr_b16 v[52:53], v4 offset:512
    v_mul_f32 v40, v110, v40
    v_mul_f32 v41, v111, v41
    v_cvt_pk_bf16_f32 v48, v38, v39
    s_setprio 0
    s_waitcnt lgkmcnt(6)
    v_mfma_f32_32x32x16_bf16 v[72:87], v[58:61], v[244:247], v[72:87]
    ds_read_b64_tr_b16 v[54:55], v4 offset:2048
    ds_read_b64_tr_b16 v[56:57], v4 offset:2560
    v_cvt_pk_bf16_f32 v49, v40, v41
    ds_write_b128 v16, v[46:49] offset:9216
    ds_read_b128 v[96:99], v18 offset:640
    s_waitcnt lgkmcnt(8)
    v_mfma_f32_32x32x16_bf16 v[72:87], v[62:65], v[248:251], v[72:87]
    ds_read_b64_tr_b16 v[58:59], v4 offset:4096
    ds_read_b64_tr_b16 v[60:61], v4 offset:4608
    ds_read_b128 v[100:103], v18 offset:672
    ds_read_b128 v[104:107], v18 offset:704
    ds_read_b128 v[108:111], v18 offset:736
    s_waitcnt lgkmcnt(11)
    v_mfma_f32_32x32x16_bf16 v[72:87], v[66:69], v[252:255], v[72:87]
    ds_read_b64_tr_b16 v[62:63], v4 offset:6144
    ds_read_b64_tr_b16 v[64:65], v4 offset:6656
    s_waitcnt vmcnt(3) lgkmcnt(8)
    s_barrier
    s_setprio 3
    s_waitcnt lgkmcnt(2)
    v_mfma_f32_32x32x16_bf16 v[96:111], v[50:53], v[112:115], v[96:111]
    ds_read_b64_tr_b16 v[66:67], v4 offset:8192
    ds_read_b64_tr_b16 v[68:69], v4 offset:8704
    s_add_u32 m0, s36, 73728
    s_add_u32 s38, s29, 384
    buffer_load_dwordx4 v13, s[8:11], s38 offen lds
    v_fmaak_f32 v34, v72, v72, 0x409d30fc
    v_fmaak_f32 v35, v73, v73, 0x409d30fc
    v_fmaak_f32 v36, v74, v74, 0x409d30fc
    v_mfma_f32_32x32x16_bf16 v[96:111], v[54:57], v[116:119], v[96:111]
    ds_read_b64_tr_b16 v[50:51], v4 offset:10240
    ds_read_b64_tr_b16 v[52:53], v4 offset:10752
    v_fmaak_f32 v37, v75, v75, 0x409d30fc
    v_mul_f32 v34, v72, v34
    v_mul_f32 v35, v73, v35
    v_mul_f32 v36, v74, v36
    v_mfma_f32_32x32x16_bf16 v[96:111], v[58:61], v[120:123], v[96:111]
    ds_read_b64_tr_b16 v[54:55], v6 offset:0
    ds_read_b64_tr_b16 v[56:57], v6 offset:512
    v_mul_f32 v37, v75, v37
    v_exp_f32 v34, -v34
    s_add_u32 m0, s36, 86016
    s_add_u32 s38, s29, 885120
    buffer_load_dwordx4 v13, s[8:11], s38 offen lds
    v_exp_f32 v35, -v35
    s_setprio 2
    s_waitcnt lgkmcnt(6)
    v_mfma_f32_32x32x16_bf16 v[96:111], v[62:65], v[124:127], v[96:111]
    ds_read_b64_tr_b16 v[58:59], v6 offset:2048
    ds_read_b64_tr_b16 v[60:61], v6 offset:2560
    v_exp_f32 v36, -v36
    v_exp_f32 v37, -v37
    v_fma_f32 v34, v34, s47, s47
    v_fma_f32 v35, v35, s47, s47
    s_waitcnt lgkmcnt(6)
    v_mfma_f32_32x32x16_bf16 v[96:111], v[66:69], v[128:131], v[96:111]
    ds_read_b64_tr_b16 v[62:63], v6 offset:4096
    ds_read_b64_tr_b16 v[64:65], v6 offset:4608
    v_fma_f32 v36, v36, s47, s47
    v_fma_f32 v37, v37, s47, s47
    v_rcp_f32 v34, v34
    v_rcp_f32 v35, v35
    s_waitcnt lgkmcnt(6)
    v_mfma_f32_32x32x16_bf16 v[96:111], v[50:53], v[132:135], v[96:111]
    ds_read_b64_tr_b16 v[66:67], v6 offset:6144
    ds_read_b64_tr_b16 v[68:69], v6 offset:6656
    s_add_u32 m0, s50, 73728
    s_add_u32 s38, s48, 384
    buffer_load_dwordx4 v13, s[8:11], s38 offen lds
    v_rcp_f32 v36, v36
    v_rcp_f32 v37, v37
    v_mul_f32 v34, v72, v34
    s_setprio 1
    s_waitcnt lgkmcnt(6)
    v_mfma_f32_32x32x16_bf16 v[96:111], v[54:57], v[136:139], v[96:111]
    ds_read_b64_tr_b16 v[50:51], v6 offset:8192
    ds_read_b64_tr_b16 v[52:53], v6 offset:8704
    v_mul_f32 v35, v73, v35
    v_mul_f32 v36, v74, v36
    v_mul_f32 v37, v75, v37
    s_waitcnt lgkmcnt(6)
    v_mfma_f32_32x32x16_bf16 v[96:111], v[58:61], v[140:143], v[96:111]
    ds_read_b64_tr_b16 v[54:55], v6 offset:10240
    ds_read_b64_tr_b16 v[56:57], v6 offset:10752
    v_cvt_pk_bf16_f32 v42, v34, v35
    v_cvt_pk_bf16_f32 v43, v36, v37
    v_fmaak_f32 v38, v76, v76, 0x409d30fc
    s_waitcnt lgkmcnt(6)
    v_mfma_f32_32x32x16_bf16 v[96:111], v[62:65], v[144:147], v[96:111]
    ds_read_b64_tr_b16 v[58:59], v4 offset:24576
    ds_read_b64_tr_b16 v[60:61], v4 offset:25088
    v_fmaak_f32 v39, v77, v77, 0x409d30fc
    v_fmaak_f32 v40, v78, v78, 0x409d30fc
    v_fmaak_f32 v41, v79, v79, 0x409d30fc
    s_setprio 0
    s_waitcnt lgkmcnt(6)
    v_mfma_f32_32x32x16_bf16 v[96:111], v[66:69], v[148:151], v[96:111]
    ds_read_b64_tr_b16 v[62:63], v4 offset:26624
    ds_read_b64_tr_b16 v[64:65], v4 offset:27136
    v_mul_f32 v38, v76, v38
    v_mul_f32 v39, v77, v39
    v_mul_f32 v40, v78, v40
    s_waitcnt lgkmcnt(6)
    v_mfma_f32_32x32x16_bf16 v[96:111], v[50:53], v[152:155], v[96:111]
    ds_read_b64_tr_b16 v[66:67], v4 offset:28672
    ds_read_b64_tr_b16 v[68:69], v4 offset:29184
    v_mul_f32 v41, v79, v41
    v_exp_f32 v38, -v38
    v_exp_f32 v39, -v39
    s_waitcnt lgkmcnt(6)
    v_mfma_f32_32x32x16_bf16 v[96:111], v[54:57], v[156:159], v[96:111]
    ds_read_b64_tr_b16 v[50:51], v4 offset:30720
    ds_read_b64_tr_b16 v[52:53], v4 offset:31232
    s_waitcnt vmcnt(3)
    s_barrier
    s_setprio 3
    s_waitcnt lgkmcnt(6)
    v_mfma_f32_32x32x16_bf16 v[96:111], v[58:61], v[160:163], v[96:111]
    ds_read_b64_tr_b16 v[54:55], v4 offset:32768
    ds_read_b64_tr_b16 v[56:57], v4 offset:33280
    s_add_u32 m0, s36, 0
    s_add_u32 s38, s29, 1769856
    buffer_load_dwordx4 v13, s[8:11], s38 offen lds
    v_exp_f32 v40, -v40
    v_exp_f32 v41, -v41
    v_fma_f32 v38, v38, s47, s47
    s_waitcnt lgkmcnt(6)
    v_mfma_f32_32x32x16_bf16 v[96:111], v[62:65], v[164:167], v[96:111]
    ds_read_b64_tr_b16 v[58:59], v4 offset:34816
    ds_read_b64_tr_b16 v[60:61], v4 offset:35328
    v_fma_f32 v39, v39, s47, s47
    v_fma_f32 v40, v40, s47, s47
    v_fma_f32 v41, v41, s47, s47
    v_rcp_f32 v38, v38
    s_waitcnt lgkmcnt(6)
    v_mfma_f32_32x32x16_bf16 v[96:111], v[66:69], v[168:171], v[96:111]
    ds_read_b64_tr_b16 v[62:63], v6 offset:24576
    ds_read_b64_tr_b16 v[64:65], v6 offset:25088
    v_rcp_f32 v39, v39
    v_rcp_f32 v40, v40
    s_add_u32 m0, s36, 12288
    s_add_u32 s38, s29, 2654592
    buffer_load_dwordx4 v13, s[8:11], s38 offen lds
    v_rcp_f32 v41, v41
    s_setprio 2
    s_waitcnt lgkmcnt(6)
    v_mfma_f32_32x32x16_bf16 v[96:111], v[50:53], v[172:175], v[96:111]
    ds_read_b64_tr_b16 v[66:67], v6 offset:26624
    ds_read_b64_tr_b16 v[68:69], v6 offset:27136
    v_mul_f32 v38, v76, v38
    v_mul_f32 v39, v77, v39
    v_mul_f32 v40, v78, v40
    v_mul_f32 v41, v79, v41
    s_waitcnt lgkmcnt(6)
    v_mfma_f32_32x32x16_bf16 v[96:111], v[54:57], v[176:179], v[96:111]
    ds_read_b64_tr_b16 v[50:51], v6 offset:28672
    ds_read_b64_tr_b16 v[52:53], v6 offset:29184
    v_cvt_pk_bf16_f32 v44, v38, v39
    v_cvt_pk_bf16_f32 v45, v40, v41
    ds_write_b128 v16, v[42:45] offset:24576
    v_fmaak_f32 v34, v80, v80, 0x409d30fc
    s_waitcnt lgkmcnt(7)
    v_mfma_f32_32x32x16_bf16 v[96:111], v[58:61], v[180:183], v[96:111]
    ds_read_b64_tr_b16 v[54:55], v6 offset:30720
    ds_read_b64_tr_b16 v[56:57], v6 offset:31232
    s_add_u32 m0, s50, 0
    s_add_u32 s38, s48, 1769856
    buffer_load_dwordx4 v13, s[8:11], s38 offen lds
    v_fmaak_f32 v35, v81, v81, 0x409d30fc
    v_fmaak_f32 v36, v82, v82, 0x409d30fc
    v_fmaak_f32 v37, v83, v83, 0x409d30fc
    s_setprio 1
    s_waitcnt lgkmcnt(7)
    v_mfma_f32_32x32x16_bf16 v[96:111], v[62:65], v[184:187], v[96:111]
    ds_read_b64_tr_b16 v[58:59], v6 offset:32768
    ds_read_b64_tr_b16 v[60:61], v6 offset:33280
    v_mul_f32 v34, v80, v34
    v_mul_f32 v35, v81, v35
    v_mul_f32 v36, v82, v36
    s_waitcnt lgkmcnt(7)
    v_mfma_f32_32x32x16_bf16 v[96:111], v[66:69], v[188:191], v[96:111]
    ds_read_b64_tr_b16 v[62:63], v6 offset:34816
    ds_read_b64_tr_b16 v[64:65], v6 offset:35328
    v_mul_f32 v37, v83, v37
    v_exp_f32 v34, -v34
    v_exp_f32 v35, -v35
    s_waitcnt lgkmcnt(7)
    v_mfma_f32_32x32x16_bf16 v[96:111], v[50:53], v[192:195], v[96:111]
    ds_read_b64_tr_b16 v[66:67], v5 offset:0
    ds_read_b64_tr_b16 v[68:69], v5 offset:512
    v_exp_f32 v36, -v36
    v_exp_f32 v37, -v37
    v_fma_f32 v34, v34, s47, s47
    s_setprio 0
    s_waitcnt lgkmcnt(6)
    v_mfma_f32_32x32x16_bf16 v[96:111], v[54:57], v[196:199], v[96:111]
    ds_read_b64_tr_b16 v[50:51], v5 offset:2048
    ds_read_b64_tr_b16 v[52:53], v5 offset:2560
    v_fma_f32 v35, v35, s47, s47
    v_fma_f32 v36, v36, s47, s47
    v_fma_f32 v37, v37, s47, s47
    s_waitcnt lgkmcnt(6)
    v_mfma_f32_32x32x16_bf16 v[96:111], v[58:61], v[200:203], v[96:111]
    ds_read_b64_tr_b16 v[54:55], v5 offset:4096
    ds_read_b64_tr_b16 v[56:57], v5 offset:4608
    v_rcp_f32 v34, v34
    v_rcp_f32 v35, v35
    v_rcp_f32 v36, v36
    s_waitcnt lgkmcnt(6)
    v_mfma_f32_32x32x16_bf16 v[96:111], v[62:65], v[204:207], v[96:111]
    ds_read_b64_tr_b16 v[58:59], v5 offset:6144
    ds_read_b64_tr_b16 v[60:61], v5 offset:6656
    s_waitcnt vmcnt(3)
    s_barrier
    s_setprio 3
    s_waitcnt lgkmcnt(6)
    v_mfma_f32_32x32x16_bf16 v[96:111], v[66:69], v[208:211], v[96:111]
    ds_read_b64_tr_b16 v[62:63], v5 offset:8192
    ds_read_b64_tr_b16 v[64:65], v5 offset:8704
    s_add_u32 m0, s36, 24576
    s_add_u32 s38, s29, 3539328
    buffer_load_dwordx4 v13, s[8:11], s38 offen lds
    v_rcp_f32 v37, v37
    v_mul_f32 v34, v80, v34
    v_mul_f32 v35, v81, v35
    s_waitcnt lgkmcnt(6)
    v_mfma_f32_32x32x16_bf16 v[96:111], v[50:53], v[212:215], v[96:111]
    ds_read_b64_tr_b16 v[66:67], v5 offset:10240
    ds_read_b64_tr_b16 v[68:69], v5 offset:10752
    v_mul_f32 v36, v82, v36
    v_mul_f32 v37, v83, v37
    v_cvt_pk_bf16_f32 v46, v34, v35
    v_cvt_pk_bf16_f32 v47, v36, v37
    s_waitcnt lgkmcnt(6)
    v_mfma_f32_32x32x16_bf16 v[96:111], v[54:57], v[216:219], v[96:111]
    ds_read_b64_tr_b16 v[50:51], v7 offset:0
    ds_read_b64_tr_b16 v[52:53], v7 offset:512
    v_fmaak_f32 v38, v84, v84, 0x409d30fc
    v_fmaak_f32 v39, v85, v85, 0x409d30fc
    s_add_u32 m0, s36, 36864
    s_add_u32 s38, s29, 4424064
    buffer_load_dwordx4 v13, s[8:11], s38 offen lds
    v_fmaak_f32 v40, v86, v86, 0x409d30fc
    s_setprio 2
    s_waitcnt lgkmcnt(6)
    v_mfma_f32_32x32x16_bf16 v[96:111], v[58:61], v[220:223], v[96:111]
    ds_read_b64_tr_b16 v[54:55], v7 offset:2048
    ds_read_b64_tr_b16 v[56:57], v7 offset:2560
    v_fmaak_f32 v41, v87, v87, 0x409d30fc
    v_mul_f32 v38, v84, v38
    v_mul_f32 v39, v85, v39
    v_mul_f32 v40, v86, v40
    s_waitcnt lgkmcnt(6)
    v_mfma_f32_32x32x16_bf16 v[96:111], v[62:65], v[224:227], v[96:111]
    ds_read_b64_tr_b16 v[58:59], v7 offset:4096
    ds_read_b64_tr_b16 v[60:61], v7 offset:4608
    v_mul_f32 v41, v87, v41
    v_exp_f32 v38, -v38
    v_exp_f32 v39, -v39
    v_exp_f32 v40, -v40
    s_waitcnt lgkmcnt(6)
    v_mfma_f32_32x32x16_bf16 v[96:111], v[66:69], v[228:231], v[96:111]
    ds_read_b64_tr_b16 v[62:63], v7 offset:6144
    ds_read_b64_tr_b16 v[64:65], v7 offset:6656
    s_add_u32 m0, s50, 24576
    s_add_u32 s38, s48, 3539328
    buffer_load_dwordx4 v13, s[8:11], s38 offen lds
    v_exp_f32 v41, -v41
    v_fma_f32 v38, v38, s47, s47
    v_fma_f32 v39, v39, s47, s47
    s_setprio 1
    s_waitcnt lgkmcnt(6)
    v_mfma_f32_32x32x16_bf16 v[96:111], v[50:53], v[232:235], v[96:111]
    ds_read_b64_tr_b16 v[66:67], v7 offset:8192
    ds_read_b64_tr_b16 v[68:69], v7 offset:8704
    v_fma_f32 v40, v40, s47, s47
    v_fma_f32 v41, v41, s47, s47
    v_rcp_f32 v38, v38
    v_rcp_f32 v39, v39
    s_waitcnt lgkmcnt(6)
    v_mfma_f32_32x32x16_bf16 v[96:111], v[54:57], v[236:239], v[96:111]
    ds_read_b64_tr_b16 v[50:51], v7 offset:10240
    ds_read_b64_tr_b16 v[52:53], v7 offset:10752
    v_rcp_f32 v40, v40
    v_rcp_f32 v41, v41
    v_mul_f32 v38, v84, v38
    v_mul_f32 v39, v85, v39
    s_waitcnt lgkmcnt(6)
    v_mfma_f32_32x32x16_bf16 v[96:111], v[58:61], v[240:243], v[96:111]
    ds_read_b64_tr_b16 v[54:55], v5 offset:24576
    ds_read_b64_tr_b16 v[56:57], v5 offset:25088
    v_mul_f32 v40, v86, v40
    v_mul_f32 v41, v87, v41
    v_cvt_pk_bf16_f32 v48, v38, v39
    s_setprio 0
    s_waitcnt lgkmcnt(6)
    v_mfma_f32_32x32x16_bf16 v[96:111], v[62:65], v[244:247], v[96:111]
    ds_read_b64_tr_b16 v[58:59], v5 offset:26624
    ds_read_b64_tr_b16 v[60:61], v5 offset:27136
    v_cvt_pk_bf16_f32 v49, v40, v41
    ds_write_b128 v16, v[46:49] offset:25600
    ds_read_b128 v[72:75], v18 offset:896
    s_waitcnt lgkmcnt(8)
    v_mfma_f32_32x32x16_bf16 v[96:111], v[66:69], v[248:251], v[96:111]
    ds_read_b64_tr_b16 v[62:63], v5 offset:28672
    ds_read_b64_tr_b16 v[64:65], v5 offset:29184
    ds_read_b128 v[76:79], v18 offset:928
    ds_read_b128 v[80:83], v18 offset:960
    ds_read_b128 v[84:87], v18 offset:992
    s_waitcnt lgkmcnt(11)
    v_mfma_f32_32x32x16_bf16 v[96:111], v[50:53], v[252:255], v[96:111]
    ds_read_b64_tr_b16 v[66:67], v5 offset:30720
    ds_read_b64_tr_b16 v[68:69], v5 offset:31232
    s_waitcnt vmcnt(3) lgkmcnt(8)
    s_barrier
    s_setprio 3
    s_waitcnt lgkmcnt(2)
    v_mfma_f32_32x32x16_bf16 v[72:87], v[54:57], v[112:115], v[72:87]
    ds_read_b64_tr_b16 v[50:51], v5 offset:32768
    ds_read_b64_tr_b16 v[52:53], v5 offset:33280
    s_add_u32 m0, s36, 49152
    s_add_u32 s38, s34, 0
    buffer_load_dwordx4 v15, s[12:15], s38 offen lds
    v_add_f32 v88, v88, v26
    v_add_f32 v89, v89, v27
    v_add_f32 v90, v90, v28
    v_add_f32 v91, v91, v29
    v_add_f32 v92, v92, v30
    v_add_f32 v93, v93, v31
    v_add_f32 v94, v94, v32
    v_add_f32 v95, v95, v33
    v_mfma_f32_32x32x16_bf16 v[72:87], v[58:61], v[116:119], v[72:87]
    ds_read_b64_tr_b16 v[54:55], v5 offset:34816
    ds_read_b64_tr_b16 v[56:57], v5 offset:35328
    v_fmaak_f32 v34, v88, v88, 0x409d30fc
    v_fmaak_f32 v35, v89, v89, 0x409d30fc
    v_fmaak_f32 v36, v90, v90, 0x409d30fc
    v_fmaak_f32 v37, v91, v91, 0x409d30fc
    v_mul_f32 v34, v88, v34
    v_mul_f32 v35, v89, v35
    v_mul_f32 v36, v90, v36
    v_mul_f32 v37, v91, v37
    v_exp_f32 v34, -v34
    v_exp_f32 v35, -v35
    v_mfma_f32_32x32x16_bf16 v[72:87], v[62:65], v[120:123], v[72:87]
    ds_read_b64_tr_b16 v[58:59], v7 offset:24576
    ds_read_b64_tr_b16 v[60:61], v7 offset:25088
    s_add_u32 m0, s36, 61440
    s_add_u32 s38, s33, 110592
    buffer_load_dwordx4 v15, s[12:15], s38 offen lds
    v_exp_f32 v36, -v36
    v_exp_f32 v37, -v37
    v_fma_f32 v34, v34, s47, s47
    v_fma_f32 v35, v35, s47, s47
    v_fma_f32 v36, v36, s47, s47
    v_fma_f32 v37, v37, s47, s47
    v_rcp_f32 v34, v34
    v_rcp_f32 v35, v35
    v_rcp_f32 v36, v36
    s_setprio 2
    s_waitcnt lgkmcnt(6)
    v_mfma_f32_32x32x16_bf16 v[72:87], v[66:69], v[124:127], v[72:87]
    ds_read_b64_tr_b16 v[62:63], v7 offset:26624
    ds_read_b64_tr_b16 v[64:65], v7 offset:27136
    v_rcp_f32 v37, v37
    v_mul_f32 v34, v88, v34
    v_mul_f32 v35, v89, v35
    v_mul_f32 v36, v90, v36
    v_mul_f32 v37, v91, v37
    v_cvt_pk_bf16_f32 v42, v34, v35
    v_cvt_pk_bf16_f32 v43, v36, v37
    v_fmaak_f32 v38, v92, v92, 0x409d30fc
    v_fmaak_f32 v39, v93, v93, 0x409d30fc
    s_waitcnt lgkmcnt(6)
    v_mfma_f32_32x32x16_bf16 v[72:87], v[50:53], v[128:131], v[72:87]
    ds_read_b64_tr_b16 v[66:67], v7 offset:28672
    ds_read_b64_tr_b16 v[68:69], v7 offset:29184
    v_fmaak_f32 v40, v94, v94, 0x409d30fc
    s_cmp_eq_u32 s25, 0
    s_cbranch_scc0 K1_X_18
    s_add_u32 m0, s37, 49152
    s_add_u32 s38, s35, 0
    buffer_load_dwordx4 v15, s[12:15], s38 offen lds
K1_X_18:
    v_fmaak_f32 v41, v95, v95, 0x409d30fc
    v_mul_f32 v38, v92, v38
    v_mul_f32 v39, v93, v39
    v_mul_f32 v40, v94, v40
    v_mul_f32 v41, v95, v41
    v_exp_f32 v38, -v38
    v_exp_f32 v39, -v39
    s_waitcnt lgkmcnt(6)
    v_mfma_f32_32x32x16_bf16 v[72:87], v[54:57], v[132:135], v[72:87]
    ds_read_b64_tr_b16 v[50:51], v7 offset:30720
    ds_read_b64_tr_b16 v[52:53], v7 offset:31232
    v_exp_f32 v40, -v40
    v_exp_f32 v41, -v41
    v_fma_f32 v38, v38, s47, s47
    v_fma_f32 v39, v39, s47, s47
    v_fma_f32 v40, v40, s47, s47
    v_fma_f32 v41, v41, s47, s47
    v_rcp_f32 v38, v38
    v_rcp_f32 v39, v39
    v_rcp_f32 v40, v40
    s_setprio 1
    s_waitcnt lgkmcnt(6)
    v_mfma_f32_32x32x16_bf16 v[72:87], v[58:61], v[136:139], v[72:87]
    ds_read_b64_tr_b16 v[54:55], v7 offset:32768
    ds_read_b64_tr_b16 v[56:57], v7 offset:33280
    v_rcp_f32 v41, v41
    v_mul_f32 v38, v92, v38
    v_mul_f32 v39, v93, v39
    s_cmp_eq_u32 s25, 1
    s_cbranch_scc0 K1_X_19
    s_add_u32 m0, s37, 61440
    s_add_u32 s38, s35, 110592
    buffer_load_dwordx4 v15, s[12:15], s38 offen lds
K1_X_19:
    v_mul_f32 v40, v94, v40
    v_mul_f32 v41, v95, v41
    v_cvt_pk_bf16_f32 v44, v38, v39
    v_cvt_pk_bf16_f32 v45, v40, v41
    ds_write_b128 v25, v[42:45]
    s_waitcnt lgkmcnt(7)
    v_mfma_f32_32x32x16_bf16 v[72:87], v[62:65], v[140:143], v[72:87]
    ds_read_b64_tr_b16 v[58:59], v7 offset:34816
    ds_read_b64_tr_b16 v[60:61], v7 offset:35328
    v_fmaak_f32 v34, v96, v96, 0x409d30fc
    v_fmaak_f32 v35, v97, v97, 0x409d30fc
    v_fmaak_f32 v36, v98, v98, 0x409d30fc
    v_fmaak_f32 v37, v99, v99, 0x409d30fc
    v_mul_f32 v34, v96, v34
    v_mul_f32 v35, v97, v35
    v_mul_f32 v36, v98, v36
    v_mul_f32 v37, v99, v37
    v_exp_f32 v34, -v34
    s_waitcnt lgkmcnt(7)
    v_mfma_f32_32x32x16_bf16 v[72:87], v[66:69], v[144:147], v[72:87]
    ds_read_b64_tr_b16 v[62:63], v4 offset:0
    ds_read_b64_tr_b16 v[64:65], v4 offset:512
    v_exp_f32 v35, -v35
    v_exp_f32 v36, -v36
    v_exp_f32 v37, -v37
    v_fma_f32 v34, v34, s47, s47
    v_fma_f32 v35, v35, s47, s47
    v_fma_f32 v36, v36, s47, s47
    v_fma_f32 v37, v37, s47, s47
    v_rcp_f32 v34, v34
    v_rcp_f32 v35, v35
    s_setprio 0
    s_waitcnt lgkmcnt(7)
    v_mfma_f32_32x32x16_bf16 v[72:87], v[50:53], v[148:151], v[72:87]
    ds_read_b64_tr_b16 v[66:67], v4 offset:2048
    ds_read_b64_tr_b16 v[68:69], v4 offset:2560
    v_rcp_f32 v36, v36
    v_rcp_f32 v37, v37
    v_mul_f32 v34, v96, v34
    v_mul_f32 v35, v97, v35
    v_mul_f32 v36, v98, v36
    v_mul_f32 v37, v99, v37
    v_cvt_pk_bf16_f32 v42, v34, v35
    v_cvt_pk_bf16_f32 v43, v36, v37
    v_fmaak_f32 v38, v100, v100, 0x409d30fc
    s_waitcnt lgkmcnt(7)
    v_mfma_f32_32x32x16_bf16 v[72:87], v[54:57], v[152:155], v[72:87]
    ds_read_b64_tr_b16 v[50:51], v4 offset:4096
    ds_read_b64_tr_b16 v[52:53], v4 offset:4608
    v_fmaak_f32 v39, v101, v101, 0x409d30fc
    v_fmaak_f32 v40, v102, v102, 0x409d30fc
    v_fmaak_f32 v41, v103, v103, 0x409d30fc
    v_mul_f32 v38, v100, v38
    v_mul_f32 v39, v101, v39
    v_mul_f32 v40, v102, v40
    v_mul_f32 v41, v103, v41
    v_exp_f32 v38, -v38
    v_exp_f32 v39, -v39
    s_waitcnt lgkmcnt(6)
    v_mfma_f32_32x32x16_bf16 v[72:87], v[58:61], v[156:159], v[72:87]
    ds_read_b64_tr_b16 v[54:55], v4 offset:6144
    ds_read_b64_tr_b16 v[56:57], v4 offset:6656
    s_waitcnt vmcnt(2)
    s_barrier
    s_setprio 3
    s_waitcnt lgkmcnt(6)
    v_mfma_f32_32x32x16_bf16 v[72:87], v[62:65], v[160:163], v[72:87]
    ds_read_b64_tr_b16 v[58:59], v4 offset:8192
    ds_read_b64_tr_b16 v[60:61], v4 offset:8704
    s_add_u32 m0, s36, 73728
    s_add_u32 s38, s34, 128
    buffer_load_dwordx4 v15, s[12:15], s38 offen lds
    ds_read_b128 v[120:123], v17 offset:8192
    ds_read_b128 v[124:127], v17 offset:8448
    ds_read_b128 v[128:131], v17 offset:16384
    ds_read_b128 v[132:135], v17 offset:16640
    s_waitcnt lgkmcnt(10)
    v_mfma_f32_32x32x16_bf16 v[72:87], v[66:69], v[164:167], v[72:87]
    ds_read_b64_tr_b16 v[62:63], v4 offset:10240
    ds_read_b64_tr_b16 v[64:65], v4 offset:10752
    ds_read_b128 v[112:115], v17 offset:0
    ds_read_b128 v[116:119], v17 offset:256
    v_exp_f32 v40, -v40
    v_exp_f32 v41, -v41
    s_add_u32 m0, s36, 86016
    s_add_u32 s38, s33, 110720
    buffer_load_dwordx4 v15, s[12:15], s38 offen lds
    s_waitcnt lgkmcnt(12)
    v_mfma_f32_32x32x16_bf16 v[72:87], v[50:53], v[168:171], v[72:87]
    ds_read_b64_tr_b16 v[66:67], v6 offset:0
    ds_read_b64_tr_b16 v[68:69], v6 offset:512
    v_fma_f32 v38, v38, s47, s47
    v_fma_f32 v39, v39, s47, s47
    v_fma_f32 v40, v40, s47, s47
    v_fma_f32 v41, v41, s47, s47
    s_setprio 2
    s_waitcnt lgkmcnt(12)
    v_mfma_f32_32x32x16_bf16 v[72:87], v[54:57], v[172:175], v[72:87]
    ds_read_b64_tr_b16 v[50:51], v6 offset:2048
    ds_read_b64_tr_b16 v[52:53], v6 offset:2560
    v_rcp_f32 v38, v38
    v_rcp_f32 v39, v39
    v_rcp_f32 v40, v40
    v_rcp_f32 v41, v41
    s_waitcnt lgkmcnt(12)
    v_mfma_f32_32x32x16_bf16 v[72:87], v[58:61], v[176:179], v[72:87]
    ds_read_b64_tr_b16 v[54:55], v6 offset:4096
    ds_read_b64_tr_b16 v[56:57], v6 offset:4608
    s_cmp_eq_u32 s25, 0
    s_cbranch_scc0 K1_X_20
    s_add_u32 m0, s37, 73728
    s_add_u32 s38, s35, 128
    buffer_load_dwordx4 v15, s[12:15], s38 offen lds
K1_X_20:
    v_mul_f32 v38, v100, v38
    v_mul_f32 v39, v101, v39
    v_mul_f32 v40, v102, v40
    s_waitcnt lgkmcnt(8)
    v_mfma_f32_32x32x16_bf16 v[72:87], v[62:65], v[180:183], v[72:87]
    ds_read_b64_tr_b16 v[58:59], v6 offset:6144
    ds_read_b64_tr_b16 v[60:61], v6 offset:6656
    v_mul_f32 v41, v103, v41
    v_cvt_pk_bf16_f32 v44, v38, v39
    v_cvt_pk_bf16_f32 v45, v40, v41
    ds_write_b128 v16, v[42:45] offset:40960
    s_setprio 1
    s_waitcnt lgkmcnt(7)
    v_mfma_f32_32x32x16_bf16 v[72:87], v[66:69], v[184:187], v[72:87]
    ds_read_b64_tr_b16 v[62:63], v6 offset:8192
    ds_read_b64_tr_b16 v[64:65], v6 offset:8704
    v_fmaak_f32 v34, v104, v104, 0x409d30fc
    s_cmp_eq_u32 s25, 1
    s_cbranch_scc0 K1_X_21
    s_add_u32 m0, s37, 86016
    s_add_u32 s38, s35, 110720
    buffer_load_dwordx4 v15, s[12:15], s38 offen lds
K1_X_21:
    v_fmaak_f32 v35, v105, v105, 0x409d30fc
    v_fmaak_f32 v36, v106, v106, 0x409d30fc
    s_waitcnt lgkmcnt(7)
    v_mfma_f32_32x32x16_bf16 v[72:87], v[50:53], v[188:191], v[72:87]
    ds_read_b64_tr_b16 v[66:67], v6 offset:10240
    ds_read_b64_tr_b16 v[68:69], v6 offset:10752
    v_fmaak_f32 v37, v107, v107, 0x409d30fc
    v_mul_f32 v34, v104, v34
    v_mul_f32 v35, v105, v35
    v_mul_f32 v36, v106, v36
    s_waitcnt lgkmcnt(7)
    v_mfma_f32_32x32x16_bf16 v[72:87], v[54:57], v[192:195], v[72:87]
    ds_read_b64_tr_b16 v[50:51], v4 offset:24576
    ds_read_b64_tr_b16 v[52:53], v4 offset:25088
    v_mul_f32 v37, v107, v37
    v_exp_f32 v34, -v34
    v_exp_f32 v35, -v35
    v_exp_f32 v36, -v36
    s_setprio 0
    s_waitcnt lgkmcnt(7)
    v_mfma_f32_32x32x16_bf16 v[72:87], v[58:61], v[196:199], v[72:87]
    ds_read_b64_tr_b16 v[54:55], v4 offset:26624
    ds_read_b64_tr_b16 v[56:57], v4 offset:27136
    v_exp_f32 v37, -v37
    v_fma_f32 v34, v34, s47, s47
    v_fma_f32 v35, v35, s47, s47
    v_fma_f32 v36, v36, s47, s47
    s_waitcnt lgkmcnt(6)
    v_mfma_f32_32x32x16_bf16 v[72:87], v[62:65], v[200:203], v[72:87]
    ds_read_b64_tr_b16 v[58:59], v4 offset:28672
    ds_read_b64_tr_b16 v[60:61], v4 offset:29184
    v_fma_f32 v37, v37, s47, s47
    v_rcp_f32 v34, v34
    v_rcp_f32 v35, v35
    v_rcp_f32 v36, v36
    s_waitcnt lgkmcnt(6)
    v_mfma_f32_32x32x16_bf16 v[72:87], v[66:69], v[204:207], v[72:87]
    ds_read_b64_tr_b16 v[62:63], v4 offset:30720
    ds_read_b64_tr_b16 v[64:65], v4 offset:31232
    s_waitcnt vmcnt(2)
    s_barrier
    s_setprio 3
    s_waitcnt lgkmcnt(6)
    v_mfma_f32_32x32x16_bf16 v[72:87], v[50:53], v[208:211], v[72:87]
    ds_read_b64_tr_b16 v[66:67], v4 offset:32768
    ds_read_b64_tr_b16 v[68:69], v4 offset:33280
    s_add_u32 m0, s36, 0
    s_add_u32 s38, s33, 221184
    buffer_load_dwordx4 v15, s[12:15], s38 offen lds
    ds_read_b128 v[136:139], v17 offset:24576
    ds_read_b128 v[140:143], v17 offset:24832
    ds_read_b128 v[144:147], v17 offset:32768
    s_waitcnt lgkmcnt(9)
    v_mfma_f32_32x32x16_bf16 v[72:87], v[54:57], v[212:215], v[72:87]
    ds_read_b64_tr_b16 v[50:51], v4 offset:34816
    ds_read_b64_tr_b16 v[52:53], v4 offset:35328
    ds_read_b128 v[148:151], v17 offset:33024
    v_rcp_f32 v37, v37
    v_mul_f32 v34, v104, v34
    v_mul_f32 v35, v105, v35
    s_waitcnt lgkmcnt(10)
    v_mfma_f32_32x32x16_bf16 v[72:87], v[58:61], v[216:219], v[72:87]
    ds_read_b64_tr_b16 v[54:55], v6 offset:24576
    ds_read_b64_tr_b16 v[56:57], v6 offset:25088
    s_add_u32 m0, s36, 12288
    s_add_u32 s38, s33, 221312
    buffer_load_dwordx4 v15, s[12:15], s38 offen lds
    v_mul_f32 v36, v106, v36
    v_mul_f32 v37, v107, v37
    v_cvt_pk_bf16_f32 v46, v34, v35
    s_setprio 2
    s_waitcnt lgkmcnt(10)
    v_mfma_f32_32x32x16_bf16 v[72:87], v[62:65], v[220:223], v[72:87]
    ds_read_b64_tr_b16 v[58:59], v6 offset:26624
    ds_read_b64_tr_b16 v[60:61], v6 offset:27136
    v_cvt_pk_bf16_f32 v47, v36, v37
    v_fmaak_f32 v38, v108, v108, 0x409d30fc
    v_fmaak_f32 v39, v109, v109, 0x409d30fc
    v_fmaak_f32 v40, v110, v110, 0x409d30fc
    s_waitcnt lgkmcnt(10)
    v_mfma_f32_32x32x16_bf16 v[72:87], v[66:69], v[224:227], v[72:87]
    ds_read_b64_tr_b16 v[62:63], v6 offset:28672
    ds_read_b64_tr_b16 v[64:65], v6 offset:29184
    s_cmp_eq_u32 s25, 0
    s_cbranch_scc0 K1_X_22
    s_add_u32 m0, s37, 0
    s_add_u32 s38, s35, 221184
    buffer_load_dwordx4 v15, s[12:15], s38 offen lds
K1_X_22:
    v_fmaak_f32 v41, v111, v111, 0x409d30fc
    v_mul_f32 v38, v108, v38
    v_mul_f32 v39, v109, v39
    s_waitcnt lgkmcnt(7)
    v_mfma_f32_32x32x16_bf16 v[72:87], v[50:53], v[228:231], v[72:87]
    ds_read_b64_tr_b16 v[66:67], v6 offset:30720
    ds_read_b64_tr_b16 v[68:69], v6 offset:31232
    v_mul_f32 v40, v110, v40
    v_mul_f32 v41, v111, v41
    v_exp_f32 v38, -v38
    v_exp_f32 v39, -v39
    s_setprio 1
    s_waitcnt lgkmcnt(6)
    v_mfma_f32_32x32x16_bf16 v[72:87], v[54:57], v[232:235], v[72:87]
    ds_read_b64_tr_b16 v[50:51], v6 offset:32768
    ds_read_b64_tr_b16 v[52:53], v6 offset:33280
    s_cmp_eq_u32 s25, 1
    s_cbranch_scc0 K1_X_23
    s_add_u32 m0, s37, 12288
    s_add_u32 s38, s35, 221312
    buffer_load_dwordx4 v15, s[12:15], s38 offen lds
K1_X_23:
    v_exp_f32 v40, -v40
    v_exp_f32 v41, -v41
    v_fma_f32 v38, v38, s47, s47
    s_waitcnt lgkmcnt(6)
    v_mfma_f32_32x32x16_bf16 v[72:87], v[58:61], v[236:239], v[72:87]
    ds_read_b64_tr_b16 v[54:55], v6 offset:34816
    ds_read_b64_tr_b16 v[56:57], v6 offset:35328
    v_fma_f32 v39, v39, s47, s47
    v_fma_f32 v40, v40, s47, s47
    v_fma_f32 v41, v41, s47, s47
    v_rcp_f32 v38, v38
    s_waitcnt lgkmcnt(6)
    v_mfma_f32_32x32x16_bf16 v[72:87], v[62:65], v[240:243], v[72:87]
    ds_read_b64_tr_b16 v[58:59], v10 offset:0
    ds_read_b64_tr_b16 v[60:61], v10 offset:2048
    v_rcp_f32 v39, v39
    v_rcp_f32 v40, v40
    v_rcp_f32 v41, v41
    v_mul_f32 v38, v108, v38
    s_setprio 0
    s_waitcnt lgkmcnt(6)
    v_mfma_f32_32x32x16_bf16 v[72:87], v[66:69], v[244:247], v[72:87]
    ds_read_b64_tr_b16 v[62:63], v12 offset:0
    ds_read_b64_tr_b16 v[64:65], v12 offset:2048
    v_mul_f32 v39, v109, v39
    v_mul_f32 v40, v110, v40
    v_mul_f32 v41, v111, v41
    s_waitcnt lgkmcnt(6)
    v_mfma_f32_32x32x16_bf16 v[72:87], v[50:53], v[248:251], v[72:87]
    ds_read_b64_tr_b16 v[66:67], v10 offset:4096
    ds_read_b64_tr_b16 v[68:69], v10 offset:6144
    v_cvt_pk_bf16_f32 v48, v38, v39
    v_cvt_pk_bf16_f32 v49, v40, v41
    ds_write_b128 v16, v[46:49] offset:41984
    s_waitcnt lgkmcnt(7)
    v_mfma_f32_32x32x16_bf16 v[72:87], v[54:57], v[252:255], v[72:87]
    ds_read_b64_tr_b16 v[50:51], v12 offset:4096
    ds_read_b64_tr_b16 v[52:53], v12 offset:6144
    s_waitcnt vmcnt(2) lgkmcnt(2)
    s_barrier
    ds_read_b128 v[152:155], v17 offset:40960
    ds_read_b128 v[156:159], v17 offset:41216
    ds_read_b128 v[160:163], v17 offset:49152
    ds_read_b128 v[164:167], v17 offset:49408
    s_setprio 3
    v_mfma_f32_16x16x32_bf16 v[184:187], v[58:61], v[112:115], 0
    ds_read_b64_tr_b16 v[54:55], v10 offset:8192
    ds_read_b64_tr_b16 v[56:57], v10 offset:10240
    s_add_u32 m0, s36, 24576
    s_add_u32 s38, s34, 256
    buffer_load_dwordx4 v15, s[12:15], s38 offen lds
    v_fmaak_f32 v34, v72, v72, 0x409d30fc
    v_fmaak_f32 v35, v73, v73, 0x409d30fc
    v_mfma_f32_16x16x32_bf16 v[188:191], v[58:61], v[116:119], 0
    v_fmaak_f32 v36, v74, v74, 0x409d30fc
    v_fmaak_f32 v37, v75, v75, 0x409d30fc
    v_mul_f32 v34, v72, v34
    v_mfma_f32_16x16x32_bf16 v[192:195], v[62:65], v[112:115], 0
    ds_read_b64_tr_b16 v[58:59], v12 offset:8192
    ds_read_b64_tr_b16 v[60:61], v12 offset:10240
    v_mul_f32 v35, v73, v35
    v_mul_f32 v36, v74, v36
    v_mul_f32 v37, v75, v37
    v_mfma_f32_16x16x32_bf16 v[196:199], v[62:65], v[116:119], 0
    v_exp_f32 v34, -v34
    v_exp_f32 v35, -v35
    s_add_u32 m0, s36, 36864
    s_add_u32 s38, s33, 110848
    buffer_load_dwordx4 v15, s[12:15], s38 offen lds
    v_mfma_f32_16x16x32_bf16 v[184:187], v[66:69], v[120:123], v[184:187]
    ds_read_b64_tr_b16 v[62:63], v10 offset:12288
    ds_read_b64_tr_b16 v[64:65], v10 offset:14336
    v_exp_f32 v36, -v36
    v_exp_f32 v37, -v37
    v_mfma_f32_16x16x32_bf16 v[188:191], v[66:69], v[124:127], v[188:191]
    v_fma_f32 v34, v34, s47, s47
    v_fma_f32 v35, v35, s47, s47
    v_fma_f32 v36, v36, s47, s47
    s_setprio 2
    s_waitcnt lgkmcnt(10)
    v_mfma_f32_16x16x32_bf16 v[192:195], v[50:53], v[120:123], v[192:195]
    ds_read_b64_tr_b16 v[66:67], v12 offset:12288
    ds_read_b64_tr_b16 v[68:69], v12 offset:14336
    v_fma_f32 v37, v37, s47, s47
    v_rcp_f32 v34, v34
    v_mfma_f32_16x16x32_bf16 v[196:199], v[50:53], v[124:127], v[196:199]
    v_rcp_f32 v35, v35
    v_rcp_f32 v36, v36
    v_rcp_f32 v37, v37
    s_waitcnt lgkmcnt(6)
    v_mfma_f32_16x16x32_bf16 v[184:187], v[54:57], v[128:131], v[184:187]
    ds_read_b64_tr_b16 v[50:51], v10 offset:16384
    ds_read_b64_tr_b16 v[52:53], v10 offset:18432
    s_cmp_eq_u32 s25, 0
    s_cbranch_scc0 K1_X_24
    s_add_u32 m0, s37, 24576
    s_add_u32 s38, s35, 256
    buffer_load_dwordx4 v15, s[12:15], s38 offen lds
K1_X_24:
    v_mul_f32 v34, v72, v34
    v_mfma_f32_16x16x32_bf16 v[188:191], v[54:57], v[132:135], v[188:191]
    v_mul_f32 v35, v73, v35
    v_mul_f32 v36, v74, v36
    v_mul_f32 v37, v75, v37
    s_waitcnt lgkmcnt(6)
    v_mfma_f32_16x16x32_bf16 v[192:195], v[58:61], v[128:131], v[192:195]
    ds_read_b64_tr_b16 v[54:55], v12 offset:16384
    ds_read_b64_tr_b16 v[56:57], v12 offset:18432
    v_cvt_pk_bf16_f32 v42, v34, v35
    v_cvt_pk_bf16_f32 v43, v36, v37
    v_mfma_f32_16x16x32_bf16 v[196:199], v[58:61], v[132:135], v[196:199]
    v_fmaak_f32 v38, v76, v76, 0x409d30fc
    v_fmaak_f32 v39, v77, v77, 0x409d30fc
    v_fmaak_f32 v40, v78, v78, 0x409d30fc
    s_setprio 1
    s_waitcnt lgkmcnt(6)
    v_mfma_f32_16x16x32_bf16 v[184:187], v[62:65], v[136:139], v[184:187]
    ds_read_b64_tr_b16 v[58:59], v10 offset:20480
    ds_read_b64_tr_b16 v[60:61], v10 offset:22528
    v_fmaak_f32 v41, v79, v79, 0x409d30fc
    s_cmp_eq_u32 s25, 1
    s_cbranch_scc0 K1_X_25
    s_add_u32 m0, s37, 36864
    s_add_u32 s38, s35, 110848
    buffer_load_dwordx4 v15, s[12:15], s38 offen lds
K1_X_25:
    v_mfma_f32_16x16x32_bf16 v[188:191], v[62:65], v[140:143], v[188:191]
    v_mul_f32 v38, v76, v38
    v_mul_f32 v39, v77, v39
    v_mul_f32 v40, v78, v40
    s_waitcnt lgkmcnt(6)
    v_mfma_f32_16x16x32_bf16 v[192:195], v[66:69], v[136:139], v[192:195]
    ds_read_b64_tr_b16 v[62:63], v12 offset:20480
    ds_read_b64_tr_b16 v[64:65], v12 offset:22528
    v_mul_f32 v41, v79, v41
    v_exp_f32 v38, -v38
    v_mfma_f32_16x16x32_bf16 v[196:199], v[66:69], v[140:143], v[196:199]
    v_exp_f32 v39, -v39
    v_exp_f32 v40, -v40
    v_exp_f32 v41, -v41
    s_waitcnt lgkmcnt(6)
    v_mfma_f32_16x16x32_bf16 v[184:187], v[50:53], v[144:147], v[184:187]
    ds_read_b64_tr_b16 v[66:67], v10 offset:24576
    ds_read_b64_tr_b16 v[68:69], v10 offset:26624
    v_fma_f32 v38, v38, s47, s47
    v_fma_f32 v39, v39, s47, s47
    v_mfma_f32_16x16x32_bf16 v[188:191], v[50:53], v[148:151], v[188:191]
    v_fma_f32 v40, v40, s47, s47
    v_fma_f32 v41, v41, s47, s47
    v_rcp_f32 v38, v38
    s_setprio 0
    s_waitcnt lgkmcnt(6)
    v_mfma_f32_16x16x32_bf16 v[192:195], v[54:57], v[144:147], v[192:195]
    ds_read_b64_tr_b16 v[50:51], v12 offset:24576
    ds_read_b64_tr_b16 v[52:53], v12 offset:26624
    v_rcp_f32 v39, v39
    v_rcp_f32 v40, v40
    v_mfma_f32_16x16x32_bf16 v[196:199], v[54:57], v[148:151], v[196:199]
    v_rcp_f32 v41, v41
    v_mul_f32 v38, v76, v38
    v_mul_f32 v39, v77, v39
    s_waitcnt lgkmcnt(6)
    v_mfma_f32_16x16x32_bf16 v[184:187], v[58:61], v[152:155], v[184:187]
    ds_read_b64_tr_b16 v[54:55], v10 offset:28672
    ds_read_b64_tr_b16 v[56:57], v10 offset:30720
    v_mul_f32 v40, v78, v40
    v_mul_f32 v41, v79, v41
    v_mfma_f32_16x16x32_bf16 v[188:191], v[58:61], v[156:159], v[188:191]
    v_cvt_pk_bf16_f32 v44, v38, v39
    v_cvt_pk_bf16_f32 v45, v40, v41
    ds_write_b128 v16, v[42:45] offset:0
    s_waitcnt lgkmcnt(7)
    v_mfma_f32_16x16x32_bf16 v[192:195], v[62:65], v[152:155], v[192:195]
    ds_read_b64_tr_b16 v[58:59], v12 offset:28672
    ds_read_b64_tr_b16 v[60:61], v12 offset:30720
    v_mfma_f32_16x16x32_bf16 v[196:199], v[62:65], v[156:159], v[196:199]
    s_waitcnt vmcnt(2) lgkmcnt(2)
    s_barrier
    s_setprio 3
    v_mfma_f32_16x16x32_bf16 v[200:203], v[66:69], v[112:115], 0
    ds_read_b64_tr_b16 v[62:63], v10 offset:32768
    ds_read_b64_tr_b16 v[64:65], v10 offset:34816
    s_add_u32 m0, s36, 49152
    s_add_u32 s38, s33, 221440
    buffer_load_dwordx4 v15, s[12:15], s38 offen lds
    v_fmaak_f32 v34, v80, v80, 0x409d30fc
    v_fmaak_f32 v35, v81, v81, 0x409d30fc
    v_mfma_f32_16x16x32_bf16 v[204:207], v[66:69], v[116:119], 0
    v_fmaak_f32 v36, v82, v82, 0x409d30fc
    v_fmaak_f32 v37, v83, v83, 0x409d30fc
    v_mul_f32 v34, v80, v34
    v_mfma_f32_16x16x32_bf16 v[208:211], v[50:53], v[112:115], 0
    ds_read_b64_tr_b16 v[66:67], v12 offset:32768
    ds_read_b64_tr_b16 v[68:69], v12 offset:34816
    v_mul_f32 v35, v81, v35
    v_mul_f32 v36, v82, v36
    v_mul_f32 v37, v83, v37
    v_mfma_f32_16x16x32_bf16 v[212:215], v[50:53], v[116:119], 0
    v_exp_f32 v34, -v34
    v_exp_f32 v35, -v35
    s_add_u32 m0, s36, 61440
    s_add_u32 s38, s34, 384
    buffer_load_dwordx4 v15, s[12:15], s38 offen lds
    v_mfma_f32_16x16x32_bf16 v[200:203], v[54:57], v[120:123], v[200:203]
    ds_read_b64_tr_b16 v[50:51], v10 offset:36864
    ds_read_b64_tr_b16 v[52:53], v10 offset:38912
    v_exp_f32 v36, -v36
    v_exp_f32 v37, -v37
    v_mfma_f32_16x16x32_bf16 v[204:207], v[54:57], v[124:127], v[204:207]
    v_fma_f32 v34, v34, s47, s47
    v_fma_f32 v35, v35, s47, s47
    v_fma_f32 v36, v36, s47, s47
    s_setprio 2
    s_waitcnt lgkmcnt(6)
    v_mfma_f32_16x16x32_bf16 v[208:211], v[58:61], v[120:123], v[208:211]
    ds_read_b64_tr_b16 v[54:55], v12 offset:36864
    ds_read_b64_tr_b16 v[56:57], v12 offset:38912
    v_fma_f32 v37, v37, s47, s47
    v_rcp_f32 v34, v34
    v_mfma_f32_16x16x32_bf16 v[212:215], v[58:61], v[124:127], v[212:215]
    v_rcp_f32 v35, v35
    v_rcp_f32 v36, v36
    v_rcp_f32 v37, v37
    s_waitcnt lgkmcnt(6)
    v_mfma_f32_16x16x32_bf16 v[200:203], v[62:65], v[128:131], v[200:203]
    ds_read_b64_tr_b16 v[58:59], v10 offset:40960
    ds_read_b64_tr_b16 v[60:61], v10 offset:43008
    s_cmp_eq_u32 s25, 0
    s_cbranch_scc0 K1_X_26
    s_add_u32 m0, s37, 49152
    s_add_u32 s38, s35, 221440
    buffer_load_dwordx4 v15, s[12:15], s38 offen lds
K1_X_26:
    v_mul_f32 v34, v80, v34
    v_mfma_f32_16x16x32_bf16 v[204:207], v[62:65], v[132:135], v[204:207]
    v_mul_f32 v35, v81, v35
    v_mul_f32 v36, v82, v36
    v_mul_f32 v37, v83, v37
    s_waitcnt lgkmcnt(6)
    v_mfma_f32_16x16x32_bf16 v[208:211], v[66:69], v[128:131], v[208:211]
    ds_read_b64_tr_b16 v[62:63], v12 offset:40960
    ds_read_b64_tr_b16 v[64:65], v12 offset:43008
    v_cvt_pk_bf16_f32 v46, v34, v35
    v_cvt_pk_bf16_f32 v47, v36, v37
    v_mfma_f32_16x16x32_bf16 v[212:215], v[66:69], v[132:135], v[212:215]
    v_fmaak_f32 v38, v84, v84, 0x409d30fc
    v_fmaak_f32 v39, v85, v85, 0x409d30fc
    v_fmaak_f32 v40, v86, v86, 0x409d30fc
    s_setprio 1
    s_waitcnt lgkmcnt(6)
    v_mfma_f32_16x16x32_bf16 v[200:203], v[50:53], v[136:139], v[200:203]
    ds_read_b64_tr_b16 v[66:67], v10 offset:45056
    ds_read_b64_tr_b16 v[68:69], v10 offset:47104
    v_fmaak_f32 v41, v87, v87, 0x409d30fc
    s_cmp_eq_u32 s25, 1
    s_cbranch_scc0 K1_X_27
    s_add_u32 m0, s37, 61440
    s_add_u32 s38, s35, 384
    buffer_load_dwordx4 v15, s[12:15], s38 offen lds
K1_X_27:
    v_mfma_f32_16x16x32_bf16 v[204:207], v[50:53], v[140:143], v[204:207]
    v_mul_f32 v38, v84, v38
    v_mul_f32 v39, v85, v39
    v_mul_f32 v40, v86, v40
    s_waitcnt lgkmcnt(6)
    v_mfma_f32_16x16x32_bf16 v[208:211], v[54:57], v[136:139], v[208:211]
    ds_read_b64_tr_b16 v[50:51], v12 offset:45056
    ds_read_b64_tr_b16 v[52:53], v12 offset:47104
    v_mul_f32 v41, v87, v41
    v_exp_f32 v38, -v38
    v_mfma_f32_16x16x32_bf16 v[212:215], v[54:57], v[140:143], v[212:215]
    v_exp_f32 v39, -v39
    v_exp_f32 v40, -v40
    v_exp_f32 v41, -v41
    s_waitcnt lgkmcnt(6)
    v_mfma_f32_16x16x32_bf16 v[200:203], v[58:61], v[144:147], v[200:203]
    ds_read_b64_tr_b16 v[54:55], v9 offset:0
    ds_read_b64_tr_b16 v[56:57], v9 offset:2048
    v_fma_f32 v38, v38, s47, s47
    v_fma_f32 v39, v39, s47, s47
    v_mfma_f32_16x16x32_bf16 v[204:207], v[58:61], v[148:151], v[204:207]
    v_fma_f32 v40, v40, s47, s47
    v_fma_f32 v41, v41, s47, s47
    v_rcp_f32 v38, v38
    s_setprio 0
    s_waitcnt lgkmcnt(6)
    v_mfma_f32_16x16x32_bf16 v[208:211], v[62:65], v[144:147], v[208:211]
    ds_read_b64_tr_b16 v[58:59], v11 offset:0
    ds_read_b64_tr_b16 v[60:61], v11 offset:2048
    v_rcp_f32 v39, v39
    v_rcp_f32 v40, v40
    v_mfma_f32_16x16x32_bf16 v[212:215], v[62:65], v[148:151], v[212:215]
    v_rcp_f32 v41, v41
    v_mul_f32 v38, v84, v38
    v_mul_f32 v39, v85, v39
    s_waitcnt lgkmcnt(6)
    v_mfma_f32_16x16x32_bf16 v[200:203], v[66:69], v[152:155], v[200:203]
    ds_read_b64_tr_b16 v[62:63], v9 offset:4096
    ds_read_b64_tr_b16 v[64:65], v9 offset:6144
    v_mul_f32 v40, v86, v40
    v_mul_f32 v41, v87, v41
    v_mfma_f32_16x16x32_bf16 v[204:207], v[66:69], v[156:159], v[204:207]
    v_cvt_pk_bf16_f32 v48, v38, v39
    v_cvt_pk_bf16_f32 v49, v40, v41
    ds_write_b128 v16, v[46:49] offset:1024
    s_waitcnt lgkmcnt(7)
    v_mfma_f32_16x16x32_bf16 v[208:211], v[50:53], v[152:155], v[208:211]
    ds_read_b64_tr_b16 v[66:67], v11 offset:4096
    ds_read_b64_tr_b16 v[68:69], v11 offset:6144
    v_mfma_f32_16x16x32_bf16 v[212:215], v[50:53], v[156:159], v[212:215]
    s_waitcnt vmcnt(2) lgkmcnt(2)
    s_barrier
    ds_read_b128 v[168:171], v17 offset:0
    ds_read_b128 v[172:175], v17 offset:256
    ds_read_b128 v[176:179], v17 offset:8192
    ds_read_b128 v[180:183], v17 offset:8448
    v_add_u32 v4, 0x18000, v9
    v_add_u32 v5, 0x18000, v11
    s_setprio 3
    v_mfma_f32_16x16x32_bf16 v[184:187], v[54:57], v[160:163], v[184:187]
    ds_read_b64_tr_b16 v[50:51], v9 offset:8192
    ds_read_b64_tr_b16 v[52:53], v9 offset:10240
    v_mfma_f32_16x16x32_bf16 v[188:191], v[54:57], v[164:167], v[188:191]
    s_add_u32 m0, s36, 73728
    s_add_u32 s38, s33, 110976
    buffer_load_dwordx4 v15, s[12:15], s38 offen lds
    v_mfma_f32_16x16x32_bf16 v[192:195], v[58:61], v[160:163], v[192:195]
    ds_read_b64_tr_b16 v[54:55], v11 offset:8192
    ds_read_b64_tr_b16 v[56:57], v11 offset:10240
    v_mfma_f32_16x16x32_bf16 v[196:199], v[58:61], v[164:167], v[196:199]
    s_add_u32 m0, s36, 86016
    s_add_u32 s38, s33, 221568
    buffer_load_dwordx4 v15, s[12:15], s38 offen lds
    s_waitcnt lgkmcnt(6)
    v_mfma_f32_16x16x32_bf16 v[184:187], v[62:65], v[168:171], v[184:187]
    ds_read_b64_tr_b16 v[58:59], v9 offset:12288
    ds_read_b64_tr_b16 v[60:61], v9 offset:14336
    v_mfma_f32_16x16x32_bf16 v[188:191], v[62:65], v[172:175], v[188:191]
    s_cmp_eq_u32 s25, 0
    s_cbranch_scc0 K1_X_28
    s_add_u32 m0, s37, 73728
    s_add_u32 s38, s35, 110976
    buffer_load_dwordx4 v15, s[12:15], s38 offen lds
K1_X_28:
    s_setprio 2
    v_mfma_f32_16x16x32_bf16 v[192:195], v[66:69], v[168:171], v[192:195]
    ds_read_b64_tr_b16 v[62:63], v11 offset:12288
    ds_read_b64_tr_b16 v[64:65], v11 offset:14336
    v_mfma_f32_16x16x32_bf16 v[196:199], v[66:69], v[172:175], v[196:199]
    s_cmp_eq_u32 s25, 1
    s_cbranch_scc0 K1_X_29
    s_add_u32 m0, s37, 86016
    s_add_u32 s38, s35, 221568
    buffer_load_dwordx4 v15, s[12:15], s38 offen lds
K1_X_29:
    s_waitcnt lgkmcnt(6)
    v_mfma_f32_16x16x32_bf16 v[184:187], v[50:53], v[176:179], v[184:187]
    ds_read_b64_tr_b16 v[66:67], v9 offset:16384
    ds_read_b64_tr_b16 v[68:69], v9 offset:18432
    v_mfma_f32_16x16x32_bf16 v[188:191], v[50:53], v[180:183], v[188:191]
    s_waitcnt lgkmcnt(6)
    v_mfma_f32_16x16x32_bf16 v[192:195], v[54:57], v[176:179], v[192:195]
    ds_read_b64_tr_b16 v[50:51], v11 offset:16384
    ds_read_b64_tr_b16 v[52:53], v11 offset:18432
    v_mfma_f32_16x16x32_bf16 v[196:199], v[54:57], v[180:183], v[196:199]
    s_setprio 1
    s_waitcnt lgkmcnt(6)
    v_mfma_f32_16x16x32_bf16 v[200:203], v[58:61], v[160:163], v[200:203]
    ds_read_b64_tr_b16 v[54:55], v9 offset:20480
    ds_read_b64_tr_b16 v[56:57], v9 offset:22528
    v_mfma_f32_16x16x32_bf16 v[204:207], v[58:61], v[164:167], v[204:207]
    s_waitcnt lgkmcnt(6)
    v_mfma_f32_16x16x32_bf16 v[208:211], v[62:65], v[160:163], v[208:211]
    ds_read_b64_tr_b16 v[58:59], v11 offset:20480
    ds_read_b64_tr_b16 v[60:61], v11 offset:22528
    v_mfma_f32_16x16x32_bf16 v[212:215], v[62:65], v[164:167], v[212:215]
    s_waitcnt lgkmcnt(6)
    v_mfma_f32_16x16x32_bf16 v[200:203], v[66:69], v[168:171], v[200:203]
    ds_read_b64_tr_b16 v[62:63], v9 offset:24576
    ds_read_b64_tr_b16 v[64:65], v9 offset:26624
    v_cvt_pk_bf16_f32 v216, v184, v185
    v_cvt_pk_bf16_f32 v217, v186, v187
    v_mfma_f32_16x16x32_bf16 v[204:207], v[66:69], v[172:175], v[204:207]
    v_cvt_pk_bf16_f32 v218, v188, v189
    v_cvt_pk_bf16_f32 v219, v190, v191
    s_setprio 0
    s_waitcnt lgkmcnt(6)
    v_mfma_f32_16x16x32_bf16 v[208:211], v[50:53], v[168:171], v[208:211]
    ds_read_b64_tr_b16 v[66:67], v11 offset:24576
    ds_read_b64_tr_b16 v[68:69], v11 offset:26624
    s_mov_b32 s38, 0
    buffer_store_dwordx4 v[216:219], v20, s[16:19], s38 offen sc1
    v_mfma_f32_16x16x32_bf16 v[212:215], v[50:53], v[172:175], v[212:215]
    v_cvt_pk_bf16_f32 v220, v192, v193
    v_cvt_pk_bf16_f32 v221, v194, v195
    s_waitcnt lgkmcnt(6)
    v_mfma_f32_16x16x32_bf16 v[200:203], v[54:57], v[176:179], v[200:203]
    ds_read_b64_tr_b16 v[50:51], v9 offset:28672
    ds_read_b64_tr_b16 v[52:53], v9 offset:30720
    v_cvt_pk_bf16_f32 v222, v196, v197
    v_mfma_f32_16x16x32_bf16 v[204:207], v[54:57], v[180:183], v[204:207]
    v_cvt_pk_bf16_f32 v223, v198, v199
    s_mov_b32 s38, 65536
    buffer_store_dwordx4 v[220:223], v20, s[16:19], s38 offen sc1
    s_waitcnt lgkmcnt(6)
    v_mfma_f32_16x16x32_bf16 v[208:211], v[58:61], v[176:179], v[208:211]
    ds_read_b64_tr_b16 v[54:55], v11 offset:28672
    ds_read_b64_tr_b16 v[56:57], v11 offset:30720
    v_mfma_f32_16x16x32_bf16 v[212:215], v[58:61], v[180:183], v[212:215]
    s_waitcnt vmcnt(4)
    s_barrier
    s_setprio 3
    s_waitcnt lgkmcnt(6)
    v_mfma_f32_16x16x32_bf16 v[184:187], v[62:65], v[112:115], 0
    ds_read_b64_tr_b16 v[58:59], v9 offset:32768
    ds_read_b64_tr_b16 v[60:61], v9 offset:34816
    v_mfma_f32_16x16x32_bf16 v[188:191], v[62:65], v[116:119], 0
    s_add_u32 m0, s36, 0
    s_add_u32 s38, s34, 512
    buffer_load_dwordx4 v15, s[12:15], s38 offen lds
    s_waitcnt lgkmcnt(6)
    v_mfma_f32_16x16x32_bf16 v[192:195], v[66:69], v[112:115], 0
    ds_read_b64_tr_b16 v[62:63], v11 offset:32768
    ds_read_b64_tr_b16 v[64:65], v11 offset:34816
    v_mfma_f32_16x16x32_bf16 v[196:199], v[66:69], v[116:119], 0
    s_add_u32 m0, s36, 12288
    s_add_u32 s38, s33, 111104
    buffer_load_dwordx4 v15, s[12:15], s38 offen lds
    s_waitcnt lgkmcnt(6)
    v_mfma_f32_16x16x32_bf16 v[184:187], v[50:53], v[120:123], v[184:187]
    ds_read_b64_tr_b16 v[66:67], v9 offset:36864
    ds_read_b64_tr_b16 v[68:69], v9 offset:38912
    s_cmp_eq_u32 s25, 0
    s_cbranch_scc0 K1_X_30
    s_add_u32 m0, s37, 0
    s_add_u32 s38, s35, 512
    buffer_load_dwordx4 v15, s[12:15], s38 offen lds
K1_X_30:
    v_mfma_f32_16x16x32_bf16 v[188:191], v[50:53], v[124:127], v[188:191]
    s_cmp_eq_u32 s25, 1
    s_cbranch_scc0 K1_X_31
    s_add_u32 m0, s37, 12288
    s_add_u32 s38, s35, 111104
    buffer_load_dwordx4 v15, s[12:15], s38 offen lds
K1_X_31:
    s_setprio 2
    s_waitcnt lgkmcnt(6)
    v_mfma_f32_16x16x32_bf16 v[192:195], v[54:57], v[120:123], v[192:195]
    ds_read_b64_tr_b16 v[50:51], v11 offset:36864
    ds_read_b64_tr_b16 v[52:53], v11 offset:38912
    s_add_u32 m0, s36, 98304
    s_add_u32 s38, s33, 221696
    buffer_load_dwordx4 v15, s[12:15], s38 offen lds
    v_mfma_f32_16x16x32_bf16 v[196:199], v[54:57], v[124:127], v[196:199]
    s_add_u32 m0, s36, 110592
    s_add_u32 s38, s34, 640
    buffer_load_dwordx4 v15, s[12:15], s38 offen lds
    s_waitcnt lgkmcnt(6)
    v_mfma_f32_16x16x32_bf16 v[184:187], v[58:61], v[128:131], v[184:187]
    ds_read_b64_tr_b16 v[54:55], v9 offset:40960
    ds_read_b64_tr_b16 v[56:57], v9 offset:43008
    s_cmp_eq_u32 s25, 0
    s_cbranch_scc0 K1_X_32
    s_add_u32 m0, s37, 98304
    s_add_u32 s38, s35, 221696
    buffer_load_dwordx4 v15, s[12:15], s38 offen lds
K1_X_32:
    v_mfma_f32_16x16x32_bf16 v[188:191], v[58:61], v[132:135], v[188:191]
    s_cmp_eq_u32 s25, 1
    s_cbranch_scc0 K1_X_33
    s_add_u32 m0, s37, 110592
    s_add_u32 s38, s35, 640
    buffer_load_dwordx4 v15, s[12:15], s38 offen lds
K1_X_33:
    s_waitcnt lgkmcnt(6)
    v_mfma_f32_16x16x32_bf16 v[192:195], v[62:65], v[128:131], v[192:195]
    ds_read_b64_tr_b16 v[58:59], v11 offset:40960
    ds_read_b64_tr_b16 v[60:61], v11 offset:43008
    v_cvt_pk_bf16_f32 v224, v200, v201
    v_mfma_f32_16x16x32_bf16 v[196:199], v[62:65], v[132:135], v[196:199]
    v_cvt_pk_bf16_f32 v225, v202, v203
    s_setprio 1
    s_waitcnt lgkmcnt(6)
    v_mfma_f32_16x16x32_bf16 v[184:187], v[66:69], v[136:139], v[184:187]
    ds_read_b64_tr_b16 v[62:63], v9 offset:45056
    ds_read_b64_tr_b16 v[64:65], v9 offset:47104
    v_cvt_pk_bf16_f32 v226, v204, v205
    v_mfma_f32_16x16x32_bf16 v[188:191], v[66:69], v[140:143], v[188:191]
    v_cvt_pk_bf16_f32 v227, v206, v207
    s_waitcnt lgkmcnt(6)
    v_mfma_f32_16x16x32_bf16 v[192:195], v[50:53], v[136:139], v[192:195]
    ds_read_b64_tr_b16 v[66:67], v11 offset:45056
    ds_read_b64_tr_b16 v[68:69], v11 offset:47104
    s_mov_b32 s38, 262144
    buffer_store_dwordx4 v[224:227], v20, s[16:19], s38 offen sc1
    v_mfma_f32_16x16x32_bf16 v[196:199], v[50:53], v[140:143], v[196:199]
    v_cvt_pk_bf16_f32 v228, v208, v209
    s_waitcnt lgkmcnt(6)
    v_mfma_f32_16x16x32_bf16 v[184:187], v[54:57], v[144:147], v[184:187]
    ds_read_b64_tr_b16 v[50:51], v10 offset:0
    ds_read_b64_tr_b16 v[52:53], v10 offset:2048
    v_cvt_pk_bf16_f32 v229, v210, v211
    v_mfma_f32_16x16x32_bf16 v[188:191], v[54:57], v[148:151], v[188:191]
    v_cvt_pk_bf16_f32 v230, v212, v213
    s_setprio 0
    s_waitcnt lgkmcnt(6)
    v_mfma_f32_16x16x32_bf16 v[192:195], v[58:61], v[144:147], v[192:195]
    ds_read_b64_tr_b16 v[54:55], v12 offset:0
    ds_read_b64_tr_b16 v[56:57], v12 offset:2048
    v_mfma_f32_16x16x32_bf16 v[196:199], v[58:61], v[148:151], v[196:199]
    v_cvt_pk_bf16_f32 v231, v214, v215
    s_waitcnt lgkmcnt(6)
    v_mfma_f32_16x16x32_bf16 v[184:187], v[62:65], v[152:155], v[184:187]
    ds_read_b64_tr_b16 v[58:59], v10 offset:4096
    ds_read_b64_tr_b16 v[60:61], v10 offset:6144
    v_mfma_f32_16x16x32_bf16 v[188:191], v[62:65], v[156:159], v[188:191]
    s_mov_b32 s38, 327680
    buffer_store_dwordx4 v[228:231], v20, s[16:19], s38 offen sc1
    s_waitcnt lgkmcnt(6)
    v_mfma_f32_16x16x32_bf16 v[192:195], v[66:69], v[152:155], v[192:195]
    ds_read_b64_tr_b16 v[62:63], v12 offset:4096
    ds_read_b64_tr_b16 v[64:65], v12 offset:6144
    v_mfma_f32_16x16x32_bf16 v[196:199], v[66:69], v[156:159], v[196:199]
    s_waitcnt vmcnt(8)
    s_barrier
    s_setprio 3
    s_waitcnt lgkmcnt(6)
    v_mfma_f32_16x16x32_bf16 v[184:187], v[50:53], v[160:163], v[184:187]
    ds_read_b64_tr_b16 v[66:67], v10 offset:8192
    ds_read_b64_tr_b16 v[68:69], v10 offset:10240
    v_mfma_f32_16x16x32_bf16 v[188:191], v[50:53], v[164:167], v[188:191]
    s_add_u32 m0, s36, 24576
    s_add_u32 s38, s33, 111232
    buffer_load_dwordx4 v15, s[12:15], s38 offen lds
    s_waitcnt lgkmcnt(6)
    v_mfma_f32_16x16x32_bf16 v[192:195], v[54:57], v[160:163], v[192:195]
    ds_read_b64_tr_b16 v[50:51], v12 offset:8192
    ds_read_b64_tr_b16 v[52:53], v12 offset:10240
    v_mfma_f32_16x16x32_bf16 v[196:199], v[54:57], v[164:167], v[196:199]
    s_add_u32 m0, s36, 36864
    s_add_u32 s38, s33, 221824
    buffer_load_dwordx4 v15, s[12:15], s38 offen lds
    s_waitcnt lgkmcnt(6)
    v_mfma_f32_16x16x32_bf16 v[184:187], v[58:61], v[168:171], v[184:187]
    ds_read_b64_tr_b16 v[54:55], v10 offset:12288
    ds_read_b64_tr_b16 v[56:57], v10 offset:14336
    v_mfma_f32_16x16x32_bf16 v[188:191], v[58:61], v[172:175], v[188:191]
    s_cmp_eq_u32 s25, 0
    s_cbranch_scc0 K1_X_34
    s_add_u32 m0, s37, 24576
    s_add_u32 s38, s35, 111232
    buffer_load_dwordx4 v15, s[12:15], s38 offen lds
K1_X_34:
    s_setprio 2
    s_waitcnt lgkmcnt(6)
    v_mfma_f32_16x16x32_bf16 v[192:195], v[62:65], v[168:171], v[192:195]
    ds_read_b64_tr_b16 v[58:59], v12 offset:12288
    ds_read_b64_tr_b16 v[60:61], v12 offset:14336
    v_mfma_f32_16x16x32_bf16 v[196:199], v[62:65], v[172:175], v[196:199]
    s_cmp_eq_u32 s25, 1
    s_cbranch_scc0 K1_X_35
    s_add_u32 m0, s37, 36864
    s_add_u32 s38, s35, 221824
    buffer_load_dwordx4 v15, s[12:15], s38 offen lds
K1_X_35:
    s_waitcnt lgkmcnt(6)
    v_mfma_f32_16x16x32_bf16 v[184:187], v[66:69], v[176:179], v[184:187]
    ds_read_b64_tr_b16 v[62:63], v10 offset:16384
    ds_read_b64_tr_b16 v[64:65], v10 offset:18432
    v_mfma_f32_16x16x32_bf16 v[188:191], v[66:69], v[180:183], v[188:191]
    s_add_u32 m0, s36, 122880
    s_add_u32 s38, s34, 768
    buffer_load_dwordx4 v15, s[12:15], s38 offen lds
    s_waitcnt lgkmcnt(6)
    v_mfma_f32_16x16x32_bf16 v[192:195], v[50:53], v[176:179], v[192:195]
    ds_read_b64_tr_b16 v[66:67], v12 offset:16384
    ds_read_b64_tr_b16 v[68:69], v12 offset:18432
    v_mfma_f32_16x16x32_bf16 v[196:199], v[50:53], v[180:183], v[196:199]
    s_add_u32 m0, s36, 135168
    s_add_u32 s38, s33, 111360
    buffer_load_dwordx4 v15, s[12:15], s38 offen lds
    s_setprio 1
    s_waitcnt lgkmcnt(6)
    v_mfma_f32_16x16x32_bf16 v[200:203], v[54:57], v[112:115], 0
    ds_read_b64_tr_b16 v[50:51], v10 offset:20480
    ds_read_b64_tr_b16 v[52:53], v10 offset:22528
    v_mfma_f32_16x16x32_bf16 v[204:207], v[54:57], v[116:119], 0
    s_cmp_eq_u32 s25, 0
    s_cbranch_scc0 K1_X_36
    s_add_u32 m0, s37, 122880
    s_add_u32 s38, s35, 768
    buffer_load_dwordx4 v15, s[12:15], s38 offen lds
K1_X_36:
    s_waitcnt lgkmcnt(6)
    v_mfma_f32_16x16x32_bf16 v[208:211], v[58:61], v[112:115], 0
    ds_read_b64_tr_b16 v[54:55], v12 offset:20480
    ds_read_b64_tr_b16 v[56:57], v12 offset:22528
    v_mfma_f32_16x16x32_bf16 v[212:215], v[58:61], v[116:119], 0
    s_cmp_eq_u32 s25, 1
    s_cbranch_scc0 K1_X_37
    s_add_u32 m0, s37, 135168
    s_add_u32 s38, s35, 111360
    buffer_load_dwordx4 v15, s[12:15], s38 offen lds
K1_X_37:
    s_waitcnt lgkmcnt(6)
    v_mfma_f32_16x16x32_bf16 v[200:203], v[62:65], v[120:123], v[200:203]
    ds_read_b64_tr_b16 v[58:59], v10 offset:24576
    ds_read_b64_tr_b16 v[60:61], v10 offset:26624
    v_cvt_pk_bf16_f32 v216, v184, v185
    v_cvt_pk_bf16_f32 v217, v186, v187
    v_mfma_f32_16x16x32_bf16 v[204:207], v[62:65], v[124:127], v[204:207]
    v_cvt_pk_bf16_f32 v218, v188, v189
    v_cvt_pk_bf16_f32 v219, v190, v191
    s_setprio 0
    s_waitcnt lgkmcnt(6)
    v_mfma_f32_16x16x32_bf16 v[208:211], v[66:69], v[120:123], v[208:211]
    ds_read_b64_tr_b16 v[62:63], v12 offset:24576
    ds_read_b64_tr_b16 v[64:65], v12 offset:26624
    s_mov_b32 s38, 524288
    buffer_store_dwordx4 v[216:219], v20, s[16:19], s38 offen sc1
    v_mfma_f32_16x16x32_bf16 v[212:215], v[66:69], v[124:127], v[212:215]
    v_cvt_pk_bf16_f32 v220, v192, v193
    v_cvt_pk_bf16_f32 v221, v194, v195
    s_waitcnt lgkmcnt(6)
    v_mfma_f32_16x16x32_bf16 v[200:203], v[50:53], v[128:131], v[200:203]
    ds_read_b64_tr_b16 v[66:67], v10 offset:28672
    ds_read_b64_tr_b16 v[68:69], v10 offset:30720
    v_cvt_pk_bf16_f32 v222, v196, v197
    v_mfma_f32_16x16x32_bf16 v[204:207], v[50:53], v[132:135], v[204:207]
    v_cvt_pk_bf16_f32 v223, v198, v199
    s_mov_b32 s38, 589824
    buffer_store_dwordx4 v[220:223], v20, s[16:19], s38 offen sc1
    s_waitcnt lgkmcnt(6)
    v_mfma_f32_16x16x32_bf16 v[208:211], v[54:57], v[128:131], v[208:211]
    ds_read_b64_tr_b16 v[50:51], v12 offset:28672
    ds_read_b64_tr_b16 v[52:53], v12 offset:30720
    v_mfma_f32_16x16x32_bf16 v[212:215], v[54:57], v[132:135], v[212:215]
    s_waitcnt vmcnt(10)
    s_barrier
    s_setprio 3
    s_waitcnt lgkmcnt(6)
    v_mfma_f32_16x16x32_bf16 v[200:203], v[58:61], v[136:139], v[200:203]
    ds_read_b64_tr_b16 v[54:55], v10 offset:32768
    ds_read_b64_tr_b16 v[56:57], v10 offset:34816
    v_mfma_f32_16x16x32_bf16 v[204:207], v[58:61], v[140:143], v[204:207]
    s_add_u32 m0, s36, 49152
    s_add_u32 s38, s33, 221952
    buffer_load_dwordx4 v15, s[12:15], s38 offen lds
    s_waitcnt lgkmcnt(6)
    v_mfma_f32_16x16x32_bf16 v[208:211], v[62:65], v[136:139], v[208:211]
    ds_read_b64_tr_b16 v[58:59], v12 offset:32768
    ds_read_b64_tr_b16 v[60:61], v12 offset:34816
    v_mfma_f32_16x16x32_bf16 v[212:215], v[62:65], v[140:143], v[212:215]
    s_add_u32 m0, s36, 61440
    s_add_u32 s38, s34, 896
    buffer_load_dwordx4 v15, s[12:15], s38 offen lds
    s_waitcnt lgkmcnt(6)
    v_mfma_f32_16x16x32_bf16 v[200:203], v[66:69], v[144:147], v[200:203]
    ds_read_b64_tr_b16 v[62:63], v10 offset:36864
    ds_read_b64_tr_b16 v[64:65], v10 offset:38912
    v_mfma_f32_16x16x32_bf16 v[204:207], v[66:69], v[148:151], v[204:207]
    s_cmp_eq_u32 s25, 0
    s_cbranch_scc0 K1_X_38
    s_add_u32 m0, s37, 49152
    s_add_u32 s38, s35, 221952
    buffer_load_dwordx4 v15, s[12:15], s38 offen lds
K1_X_38:
    s_setprio 2
    s_waitcnt lgkmcnt(6)
    v_mfma_f32_16x16x32_bf16 v[208:211], v[50:53], v[144:147], v[208:211]
    ds_read_b64_tr_b16 v[66:67], v12 offset:36864
    ds_read_b64_tr_b16 v[68:69], v12 offset:38912
    v_mfma_f32_16x16x32_bf16 v[212:215], v[50:53], v[148:151], v[212:215]
    s_cmp_eq_u32 s25, 1
    s_cbranch_scc0 K1_X_39
    s_add_u32 m0, s37, 61440
    s_add_u32 s38, s35, 896
    buffer_load_dwordx4 v15, s[12:15], s38 offen lds
K1_X_39:
    s_waitcnt lgkmcnt(6)
    v_mfma_f32_16x16x32_bf16 v[200:203], v[54:57], v[152:155], v[200:203]
    ds_read_b64_tr_b16 v[50:51], v10 offset:40960
    ds_read_b64_tr_b16 v[52:53], v10 offset:43008
    v_mfma_f32_16x16x32_bf16 v[204:207], v[54:57], v[156:159], v[204:207]
    s_waitcnt lgkmcnt(6)
    v_mfma_f32_16x16x32_bf16 v[208:211], v[58:61], v[152:155], v[208:211]
    ds_read_b64_tr_b16 v[54:55], v12 offset:40960
    ds_read_b64_tr_b16 v[56:57], v12 offset:43008
    v_mfma_f32_16x16x32_bf16 v[212:215], v[58:61], v[156:159], v[212:215]
    s_setprio 1
    s_waitcnt lgkmcnt(6)
    v_mfma_f32_16x16x32_bf16 v[200:203], v[62:65], v[160:163], v[200:203]
    ds_read_b64_tr_b16 v[58:59], v10 offset:45056
    ds_read_b64_tr_b16 v[60:61], v10 offset:47104
    v_mfma_f32_16x16x32_bf16 v[204:207], v[62:65], v[164:167], v[204:207]
    s_waitcnt lgkmcnt(6)
    v_mfma_f32_16x16x32_bf16 v[208:211], v[66:69], v[160:163], v[208:211]
    ds_read_b64_tr_b16 v[62:63], v12 offset:45056
    ds_read_b64_tr_b16 v[64:65], v12 offset:47104
    v_mfma_f32_16x16x32_bf16 v[212:215], v[66:69], v[164:167], v[212:215]
    s_waitcnt lgkmcnt(6)
    v_mfma_f32_16x16x32_bf16 v[200:203], v[50:53], v[168:171], v[200:203]
    ds_read_b64_tr_b16 v[66:67], v9 offset:0
    ds_read_b64_tr_b16 v[68:69], v9 offset:2048
    v_mfma_f32_16x16x32_bf16 v[204:207], v[50:53], v[172:175], v[204:207]
    s_setprio 0
    s_waitcnt lgkmcnt(6)
    v_mfma_f32_16x16x32_bf16 v[208:211], v[54:57], v[168:171], v[208:211]
    ds_read_b64_tr_b16 v[50:51], v11 offset:0
    ds_read_b64_tr_b16 v[52:53], v11 offset:2048
    v_mfma_f32_16x16x32_bf16 v[212:215], v[54:57], v[172:175], v[212:215]
    s_waitcnt lgkmcnt(6)
    v_mfma_f32_16x16x32_bf16 v[200:203], v[58:61], v[176:179], v[200:203]
    ds_read_b64_tr_b16 v[54:55], v9 offset:4096
    ds_read_b64_tr_b16 v[56:57], v9 offset:6144
    v_mfma_f32_16x16x32_bf16 v[204:207], v[58:61], v[180:183], v[204:207]
    s_waitcnt lgkmcnt(6)
    v_mfma_f32_16x16x32_bf16 v[208:211], v[62:65], v[176:179], v[208:211]
    ds_read_b64_tr_b16 v[58:59], v11 offset:4096
    ds_read_b64_tr_b16 v[60:61], v11 offset:6144
    v_mfma_f32_16x16x32_bf16 v[212:215], v[62:65], v[180:183], v[212:215]
    s_waitcnt vmcnt(10)
    s_barrier
    s_setprio 3
    s_waitcnt lgkmcnt(6)
    v_mfma_f32_16x16x32_bf16 v[184:187], v[66:69], v[112:115], 0
    ds_read_b64_tr_b16 v[62:63], v9 offset:8192
    ds_read_b64_tr_b16 v[64:65], v9 offset:10240
    v_mfma_f32_16x16x32_bf16 v[188:191], v[66:69], v[116:119], 0
    s_add_u32 m0, s36, 73728
    s_add_u32 s38, s33, 111488
    buffer_load_dwordx4 v15, s[12:15], s38 offen lds
    s_waitcnt lgkmcnt(6)
    v_mfma_f32_16x16x32_bf16 v[192:195], v[50:53], v[112:115], 0
    ds_read_b64_tr_b16 v[66:67], v11 offset:8192
    ds_read_b64_tr_b16 v[68:69], v11 offset:10240
    v_mfma_f32_16x16x32_bf16 v[196:199], v[50:53], v[116:119], 0
    s_add_u32 m0, s36, 86016
    s_add_u32 s38, s33, 222080
    buffer_load_dwordx4 v15, s[12:15], s38 offen lds
    s_waitcnt lgkmcnt(6)
    v_mfma_f32_16x16x32_bf16 v[184:187], v[54:57], v[120:123], v[184:187]
    ds_read_b64_tr_b16 v[50:51], v9 offset:12288
    ds_read_b64_tr_b16 v[52:53], v9 offset:14336
    s_cmp_eq_u32 s25, 0
    s_cbranch_scc0 K1_X_40
    s_add_u32 m0, s37, 73728
    s_add_u32 s38, s35, 111488
    buffer_load_dwordx4 v15, s[12:15], s38 offen lds
K1_X_40:
    v_mfma_f32_16x16x32_bf16 v[188:191], v[54:57], v[124:127], v[188:191]
    s_cmp_eq_u32 s25, 1
    s_cbranch_scc0 K1_X_41
    s_add_u32 m0, s37, 86016
    s_add_u32 s38, s35, 222080
    buffer_load_dwordx4 v15, s[12:15], s38 offen lds
K1_X_41:
    s_setprio 2
    s_waitcnt lgkmcnt(6)
    v_mfma_f32_16x16x32_bf16 v[192:195], v[58:61], v[120:123], v[192:195]
    ds_read_b64_tr_b16 v[54:55], v11 offset:12288
    ds_read_b64_tr_b16 v[56:57], v11 offset:14336
    v_cvt_pk_bf16_f32 v224, v200, v201
    v_mfma_f32_16x16x32_bf16 v[196:199], v[58:61], v[124:127], v[196:199]
    v_cvt_pk_bf16_f32 v225, v202, v203
    s_waitcnt lgkmcnt(6)
    v_mfma_f32_16x16x32_bf16 v[184:187], v[62:65], v[128:131], v[184:187]
    ds_read_b64_tr_b16 v[58:59], v9 offset:16384
    ds_read_b64_tr_b16 v[60:61], v9 offset:18432
    v_cvt_pk_bf16_f32 v226, v204, v205
    v_mfma_f32_16x16x32_bf16 v[188:191], v[62:65], v[132:135], v[188:191]
    v_cvt_pk_bf16_f32 v227, v206, v207
    s_waitcnt lgkmcnt(6)
    v_mfma_f32_16x16x32_bf16 v[192:195], v[66:69], v[128:131], v[192:195]
    ds_read_b64_tr_b16 v[62:63], v11 offset:16384
    ds_read_b64_tr_b16 v[64:65], v11 offset:18432
    v_mfma_f32_16x16x32_bf16 v[196:199], v[66:69], v[132:135], v[196:199]
    s_mov_b32 s38, 786432
    buffer_store_dwordx4 v[224:227], v20, s[16:19], s38 offen sc1
    s_setprio 1
    s_waitcnt lgkmcnt(6)
    v_mfma_f32_16x16x32_bf16 v[184:187], v[50:53], v[136:139], v[184:187]
    ds_read_b64_tr_b16 v[66:67], v9 offset:20480
    ds_read_b64_tr_b16 v[68:69], v9 offset:22528
    v_mfma_f32_16x16x32_bf16 v[188:191], v[50:53], v[140:143], v[188:191]
    v_cvt_pk_bf16_f32 v228, v208, v209
    s_waitcnt lgkmcnt(6)
    v_mfma_f32_16x16x32_bf16 v[192:195], v[54:57], v[136:139], v[192:195]
    ds_read_b64_tr_b16 v[50:51], v11 offset:20480
    ds_read_b64_tr_b16 v[52:53], v11 offset:22528
    v_mfma_f32_16x16x32_bf16 v[196:199], v[54:57], v[140:143], v[196:199]
    v_cvt_pk_bf16_f32 v229, v210, v211
    s_waitcnt lgkmcnt(6)
    v_mfma_f32_16x16x32_bf16 v[184:187], v[58:61], v[144:147], v[184:187]
    ds_read_b64_tr_b16 v[54:55], v4 offset:0
    ds_read_b64_tr_b16 v[56:57], v4 offset:2048
    v_mfma_f32_16x16x32_bf16 v[188:191], v[58:61], v[148:151], v[188:191]
    v_cvt_pk_bf16_f32 v230, v212, v213
    s_setprio 0
    s_waitcnt lgkmcnt(6)
    v_mfma_f32_16x16x32_bf16 v[192:195], v[62:65], v[144:147], v[192:195]
    ds_read_b64_tr_b16 v[58:59], v5 offset:0
    ds_read_b64_tr_b16 v[60:61], v5 offset:2048
    v_mfma_f32_16x16x32_bf16 v[196:199], v[62:65], v[148:151], v[196:199]
    v_cvt_pk_bf16_f32 v231, v214, v215
    s_waitcnt lgkmcnt(6)
    v_mfma_f32_16x16x32_bf16 v[184:187], v[66:69], v[152:155], v[184:187]
    ds_read_b64_tr_b16 v[62:63], v4 offset:4096
    ds_read_b64_tr_b16 v[64:65], v4 offset:6144
    v_mfma_f32_16x16x32_bf16 v[188:191], v[66:69], v[156:159], v[188:191]
    s_mov_b32 s38, 851968
    buffer_store_dwordx4 v[228:231], v20, s[16:19], s38 offen sc1
    s_waitcnt lgkmcnt(6)
    v_mfma_f32_16x16x32_bf16 v[192:195], v[50:53], v[152:155], v[192:195]
    ds_read_b64_tr_b16 v[66:67], v5 offset:4096
    ds_read_b64_tr_b16 v[68:69], v5 offset:6144
    v_mfma_f32_16x16x32_bf16 v[196:199], v[50:53], v[156:159], v[196:199]
    s_waitcnt vmcnt(10)
    s_barrier
    s_setprio 3
    s_waitcnt lgkmcnt(6)
    v_mfma_f32_16x16x32_bf16 v[184:187], v[54:57], v[160:163], v[184:187]
    ds_read_b64_tr_b16 v[50:51], v4 offset:8192
    ds_read_b64_tr_b16 v[52:53], v4 offset:10240
    v_mfma_f32_16x16x32_bf16 v[188:191], v[54:57], v[164:167], v[188:191]
    s_add_u32 m0, s36, 0
    s_add_u32 s38, s34, 1024
    buffer_load_dwordx4 v15, s[12:15], s38 offen lds
    s_waitcnt lgkmcnt(6)
    v_mfma_f32_16x16x32_bf16 v[192:195], v[58:61], v[160:163], v[192:195]
    ds_read_b64_tr_b16 v[54:55], v5 offset:8192
    ds_read_b64_tr_b16 v[56:57], v5 offset:10240
    v_mfma_f32_16x16x32_bf16 v[196:199], v[58:61], v[164:167], v[196:199]
    s_add_u32 m0, s36, 12288
    s_add_u32 s38, s33, 111616
    buffer_load_dwordx4 v15, s[12:15], s38 offen lds
    s_waitcnt lgkmcnt(6)
    v_mfma_f32_16x16x32_bf16 v[184:187], v[62:65], v[168:171], v[184:187]
    ds_read_b64_tr_b16 v[58:59], v4 offset:12288
    ds_read_b64_tr_b16 v[60:61], v4 offset:14336
    v_mfma_f32_16x16x32_bf16 v[188:191], v[62:65], v[172:175], v[188:191]
    s_cmp_eq_u32 s25, 0
    s_cbranch_scc0 K1_X_42
    s_add_u32 m0, s37, 0
    s_add_u32 s38, s35, 1024
    buffer_load_dwordx4 v15, s[12:15], s38 offen lds
K1_X_42:
    s_setprio 2
    s_waitcnt lgkmcnt(6)
    v_mfma_f32_16x16x32_bf16 v[192:195], v[66:69], v[168:171], v[192:195]
    ds_read_b64_tr_b16 v[62:63], v5 offset:12288
    ds_read_b64_tr_b16 v[64:65], v5 offset:14336
    v_mfma_f32_16x16x32_bf16 v[196:199], v[66:69], v[172:175], v[196:199]
    s_cmp_eq_u32 s25, 1
    s_cbranch_scc0 K1_X_43
    s_add_u32 m0, s37, 12288
    s_add_u32 s38, s35, 111616
    buffer_load_dwordx4 v15, s[12:15], s38 offen lds
K1_X_43:
    s_waitcnt lgkmcnt(6)
    v_mfma_f32_16x16x32_bf16 v[184:187], v[50:53], v[176:179], v[184:187]
    ds_read_b64_tr_b16 v[66:67], v4 offset:16384
    ds_read_b64_tr_b16 v[68:69], v4 offset:18432
    v_mfma_f32_16x16x32_bf16 v[188:191], v[50:53], v[180:183], v[188:191]
    s_waitcnt lgkmcnt(6)
    v_mfma_f32_16x16x32_bf16 v[192:195], v[54:57], v[176:179], v[192:195]
    ds_read_b64_tr_b16 v[50:51], v5 offset:16384
    ds_read_b64_tr_b16 v[52:53], v5 offset:18432
    v_mfma_f32_16x16x32_bf16 v[196:199], v[54:57], v[180:183], v[196:199]
    s_setprio 1
    s_waitcnt lgkmcnt(6)
    v_mfma_f32_16x16x32_bf16 v[200:203], v[58:61], v[112:115], 0
    ds_read_b64_tr_b16 v[54:55], v4 offset:20480
    ds_read_b64_tr_b16 v[56:57], v4 offset:22528
    v_mfma_f32_16x16x32_bf16 v[204:207], v[58:61], v[116:119], 0
    s_waitcnt lgkmcnt(6)
    v_mfma_f32_16x16x32_bf16 v[208:211], v[62:65], v[112:115], 0
    ds_read_b64_tr_b16 v[58:59], v5 offset:20480
    ds_read_b64_tr_b16 v[60:61], v5 offset:22528
    v_mfma_f32_16x16x32_bf16 v[212:215], v[62:65], v[116:119], 0
    s_waitcnt lgkmcnt(6)
    v_mfma_f32_16x16x32_bf16 v[200:203], v[66:69], v[120:123], v[200:203]
    ds_read_b64_tr_b16 v[62:63], v9 offset:24576
    ds_read_b64_tr_b16 v[64:65], v9 offset:26624
    v_cvt_pk_bf16_f32 v216, v184, v185
    v_cvt_pk_bf16_f32 v217, v186, v187
    v_mfma_f32_16x16x32_bf16 v[204:207], v[66:69], v[124:127], v[204:207]
    v_cvt_pk_bf16_f32 v218, v188, v189
    v_cvt_pk_bf16_f32 v219, v190, v191
    s_setprio 0
    s_waitcnt lgkmcnt(6)
    v_mfma_f32_16x16x32_bf16 v[208:211], v[50:53], v[120:123], v[208:211]
    ds_read_b64_tr_b16 v[66:67], v11 offset:24576
    ds_read_b64_tr_b16 v[68:69], v11 offset:26624
    s_mov_b32 s38, 1048576
    buffer_store_dwordx4 v[216:219], v20, s[16:19], s38 offen sc1
    v_mfma_f32_16x16x32_bf16 v[212:215], v[50:53], v[124:127], v[212:215]
    v_cvt_pk_bf16_f32 v220, v192, v193
    v_cvt_pk_bf16_f32 v221, v194, v195
    s_waitcnt lgkmcnt(6)
    v_mfma_f32_16x16x32_bf16 v[200:203], v[54:57], v[128:131], v[200:203]
    ds_read_b64_tr_b16 v[50:51], v9 offset:28672
    ds_read_b64_tr_b16 v[52:53], v9 offset:30720
    v_cvt_pk_bf16_f32 v222, v196, v197
    v_mfma_f32_16x16x32_bf16 v[204:207], v[54:57], v[132:135], v[204:207]
    v_cvt_pk_bf16_f32 v223, v198, v199
    s_mov_b32 s38, 1114112
    buffer_store_dwordx4 v[220:223], v20, s[16:19], s38 offen sc1
    s_waitcnt lgkmcnt(6)
    v_mfma_f32_16x16x32_bf16 v[208:211], v[58:61], v[128:131], v[208:211]
    ds_read_b64_tr_b16 v[54:55], v11 offset:28672
    ds_read_b64_tr_b16 v[56:57], v11 offset:30720
    v_mfma_f32_16x16x32_bf16 v[212:215], v[58:61], v[132:135], v[212:215]
    s_waitcnt vmcnt(12)
    s_barrier
    s_setprio 3
    s_waitcnt lgkmcnt(6)
    v_mfma_f32_16x16x32_bf16 v[200:203], v[62:65], v[136:139], v[200:203]
    ds_read_b64_tr_b16 v[58:59], v9 offset:32768
    ds_read_b64_tr_b16 v[60:61], v9 offset:34816
    v_mfma_f32_16x16x32_bf16 v[204:207], v[62:65], v[140:143], v[204:207]
    s_add_u32 m0, s36, 98304
    s_add_u32 s38, s33, 222208
    buffer_load_dwordx4 v15, s[12:15], s38 offen lds
    s_waitcnt lgkmcnt(6)
    v_mfma_f32_16x16x32_bf16 v[208:211], v[66:69], v[136:139], v[208:211]
    ds_read_b64_tr_b16 v[62:63], v11 offset:32768
    ds_read_b64_tr_b16 v[64:65], v11 offset:34816
    v_mfma_f32_16x16x32_bf16 v[212:215], v[66:69], v[140:143], v[212:215]
    s_cmp_eq_u32 s25, 0
    s_cbranch_scc0 K1_X_44
    s_add_u32 m0, s37, 98304
    s_add_u32 s38, s35, 222208
    buffer_load_dwordx4 v15, s[12:15], s38 offen lds
K1_X_44:
    s_waitcnt lgkmcnt(6)
    v_mfma_f32_16x16x32_bf16 v[200:203], v[50:53], v[144:147], v[200:203]
    ds_read_b64_tr_b16 v[66:67], v9 offset:36864
    ds_read_b64_tr_b16 v[68:69], v9 offset:38912
    v_mfma_f32_16x16x32_bf16 v[204:207], v[50:53], v[148:151], v[204:207]
    s_setprio 2
    s_waitcnt lgkmcnt(6)
    v_mfma_f32_16x16x32_bf16 v[208:211], v[54:57], v[144:147], v[208:211]
    ds_read_b64_tr_b16 v[50:51], v11 offset:36864
    ds_read_b64_tr_b16 v[52:53], v11 offset:38912
    v_mfma_f32_16x16x32_bf16 v[212:215], v[54:57], v[148:151], v[212:215]
    s_waitcnt lgkmcnt(6)
    v_mfma_f32_16x16x32_bf16 v[200:203], v[58:61], v[152:155], v[200:203]
    ds_read_b64_tr_b16 v[54:55], v9 offset:40960
    ds_read_b64_tr_b16 v[56:57], v9 offset:43008
    v_mfma_f32_16x16x32_bf16 v[204:207], v[58:61], v[156:159], v[204:207]
    s_waitcnt lgkmcnt(6)
    v_mfma_f32_16x16x32_bf16 v[208:211], v[62:65], v[152:155], v[208:211]
    ds_read_b64_tr_b16 v[58:59], v11 offset:40960
    ds_read_b64_tr_b16 v[60:61], v11 offset:43008
    v_mfma_f32_16x16x32_bf16 v[212:215], v[62:65], v[156:159], v[212:215]
    s_setprio 1
    s_waitcnt lgkmcnt(6)
    v_mfma_f32_16x16x32_bf16 v[200:203], v[66:69], v[160:163], v[200:203]
    ds_read_b64_tr_b16 v[62:63], v9 offset:45056
    ds_read_b64_tr_b16 v[64:65], v9 offset:47104
    v_mfma_f32_16x16x32_bf16 v[204:207], v[66:69], v[164:167], v[204:207]
    s_waitcnt lgkmcnt(6)
    v_mfma_f32_16x16x32_bf16 v[208:211], v[50:53], v[160:163], v[208:211]
    ds_read_b64_tr_b16 v[66:67], v11 offset:45056
    ds_read_b64_tr_b16 v[68:69], v11 offset:47104
    v_mfma_f32_16x16x32_bf16 v[212:215], v[50:53], v[164:167], v[212:215]
    s_waitcnt lgkmcnt(6)
    v_mfma_f32_16x16x32_bf16 v[200:203], v[54:57], v[168:171], v[200:203]
    ds_read_b64_tr_b16 v[50:51], v4 offset:24576
    ds_read_b64_tr_b16 v[52:53], v4 offset:26624
    v_mfma_f32_16x16x32_bf16 v[204:207], v[54:57], v[172:175], v[204:207]
    s_setprio 0
    s_waitcnt lgkmcnt(6)
    v_mfma_f32_16x16x32_bf16 v[208:211], v[58:61], v[168:171], v[208:211]
    ds_read_b64_tr_b16 v[54:55], v5 offset:24576
    ds_read_b64_tr_b16 v[56:57], v5 offset:26624
    v_mfma_f32_16x16x32_bf16 v[212:215], v[58:61], v[172:175], v[212:215]
    s_waitcnt lgkmcnt(6)
    v_mfma_f32_16x16x32_bf16 v[200:203], v[62:65], v[176:179], v[200:203]
    ds_read_b64_tr_b16 v[58:59], v4 offset:28672
    ds_read_b64_tr_b16 v[60:61], v4 offset:30720
    v_mfma_f32_16x16x32_bf16 v[204:207], v[62:65], v[180:183], v[204:207]
    s_waitcnt lgkmcnt(6)
    v_mfma_f32_16x16x32_bf16 v[208:211], v[66:69], v[176:179], v[208:211]
    ds_read_b64_tr_b16 v[62:63], v5 offset:28672
    ds_read_b64_tr_b16 v[64:65], v5 offset:30720
    v_mfma_f32_16x16x32_bf16 v[212:215], v[66:69], v[180:183], v[212:215]
    s_waitcnt vmcnt(9)
    s_barrier
    s_setprio 3
    s_waitcnt lgkmcnt(6)
    v_mfma_f32_16x16x32_bf16 v[184:187], v[50:53], v[112:115], 0
    ds_read_b64_tr_b16 v[66:67], v4 offset:32768
    ds_read_b64_tr_b16 v[68:69], v4 offset:34816
    v_mfma_f32_16x16x32_bf16 v[188:191], v[50:53], v[116:119], 0
    s_waitcnt lgkmcnt(6)
    v_mfma_f32_16x16x32_bf16 v[192:195], v[54:57], v[112:115], 0
    ds_read_b64_tr_b16 v[50:51], v5 offset:32768
    ds_read_b64_tr_b16 v[52:53], v5 offset:34816
    v_mfma_f32_16x16x32_bf16 v[196:199], v[54:57], v[116:119], 0
    s_waitcnt lgkmcnt(6)
    v_mfma_f32_16x16x32_bf16 v[184:187], v[58:61], v[120:123], v[184:187]
    ds_read_b64_tr_b16 v[54:55], v4 offset:36864
    ds_read_b64_tr_b16 v[56:57], v4 offset:38912
    v_cvt_pk_bf16_f32 v224, v200, v201
    v_mfma_f32_16x16x32_bf16 v[188:191], v[58:61], v[124:127], v[188:191]
    v_cvt_pk_bf16_f32 v225, v202, v203
    s_setprio 2
    s_waitcnt lgkmcnt(6)
    v_mfma_f32_16x16x32_bf16 v[192:195], v[62:65], v[120:123], v[192:195]
    ds_read_b64_tr_b16 v[58:59], v5 offset:36864
    ds_read_b64_tr_b16 v[60:61], v5 offset:38912
    v_mfma_f32_16x16x32_bf16 v[196:199], v[62:65], v[124:127], v[196:199]
    v_cvt_pk_bf16_f32 v226, v204, v205
    s_waitcnt lgkmcnt(6)
    v_mfma_f32_16x16x32_bf16 v[184:187], v[66:69], v[128:131], v[184:187]
    ds_read_b64_tr_b16 v[62:63], v4 offset:40960
    ds_read_b64_tr_b16 v[64:65], v4 offset:43008
    v_mfma_f32_16x16x32_bf16 v[188:191], v[66:69], v[132:135], v[188:191]
    v_cvt_pk_bf16_f32 v227, v206, v207
    s_waitcnt lgkmcnt(6)
    v_mfma_f32_16x16x32_bf16 v[192:195], v[50:53], v[128:131], v[192:195]
    ds_read_b64_tr_b16 v[66:67], v5 offset:40960
    ds_read_b64_tr_b16 v[68:69], v5 offset:43008
    v_mfma_f32_16x16x32_bf16 v[196:199], v[50:53], v[132:135], v[196:199]
    s_mov_b32 s38, 1310720
    buffer_store_dwordx4 v[224:227], v20, s[16:19], s38 offen sc1
    s_setprio 1
    s_waitcnt lgkmcnt(6)
    v_mfma_f32_16x16x32_bf16 v[184:187], v[54:57], v[136:139], v[184:187]
    ds_read_b64_tr_b16 v[50:51], v4 offset:45056
    ds_read_b64_tr_b16 v[52:53], v4 offset:47104
    v_mfma_f32_16x16x32_bf16 v[188:191], v[54:57], v[140:143], v[188:191]
    v_cvt_pk_bf16_f32 v228, v208, v209
    s_waitcnt lgkmcnt(6)
    v_mfma_f32_16x16x32_bf16 v[192:195], v[58:61], v[136:139], v[192:195]
    ds_read_b64_tr_b16 v[54:55], v5 offset:45056
    ds_read_b64_tr_b16 v[56:57], v5 offset:47104
    v_mfma_f32_16x16x32_bf16 v[196:199], v[58:61], v[140:143], v[196:199]
    v_cvt_pk_bf16_f32 v229, v210, v211
    s_waitcnt lgkmcnt(6)
    v_mfma_f32_16x16x32_bf16 v[184:187], v[62:65], v[144:147], v[184:187]
    ds_read_b64_tr_b16 v[58:59], v10 offset:0
    ds_read_b64_tr_b16 v[60:61], v10 offset:2048
    v_mfma_f32_16x16x32_bf16 v[188:191], v[62:65], v[148:151], v[188:191]
    v_cvt_pk_bf16_f32 v230, v212, v213
    s_setprio 0
    s_waitcnt lgkmcnt(6)
    v_mfma_f32_16x16x32_bf16 v[192:195], v[66:69], v[144:147], v[192:195]
    ds_read_b64_tr_b16 v[62:63], v12 offset:0
    ds_read_b64_tr_b16 v[64:65], v12 offset:2048
    v_mfma_f32_16x16x32_bf16 v[196:199], v[66:69], v[148:151], v[196:199]
    v_cvt_pk_bf16_f32 v231, v214, v215
    s_waitcnt lgkmcnt(6)
    v_mfma_f32_16x16x32_bf16 v[184:187], v[50:53], v[152:155], v[184:187]
    ds_read_b64_tr_b16 v[66:67], v10 offset:4096
    ds_read_b64_tr_b16 v[68:69], v10 offset:6144
    v_mfma_f32_16x16x32_bf16 v[188:191], v[50:53], v[156:159], v[188:191]
    s_mov_b32 s38, 1376256
    buffer_store_dwordx4 v[228:231], v20, s[16:19], s38 offen sc1
    s_waitcnt lgkmcnt(6)
    v_mfma_f32_16x16x32_bf16 v[192:195], v[54:57], v[152:155], v[192:195]
    ds_read_b64_tr_b16 v[50:51], v12 offset:4096
    ds_read_b64_tr_b16 v[52:53], v12 offset:6144
    v_mfma_f32_16x16x32_bf16 v[196:199], v[54:57], v[156:159], v[196:199]
    s_waitcnt vmcnt(9)
    s_barrier
    s_setprio 3
    s_waitcnt lgkmcnt(6)
    v_mfma_f32_16x16x32_bf16 v[184:187], v[58:61], v[160:163], v[184:187]
    ds_read_b64_tr_b16 v[54:55], v10 offset:8192
    ds_read_b64_tr_b16 v[56:57], v10 offset:10240
    v_mfma_f32_16x16x32_bf16 v[188:191], v[58:61], v[164:167], v[188:191]
    s_waitcnt lgkmcnt(6)
    v_mfma_f32_16x16x32_bf16 v[192:195], v[62:65], v[160:163], v[192:195]
    ds_read_b64_tr_b16 v[58:59], v12 offset:8192
    ds_read_b64_tr_b16 v[60:61], v12 offset:10240
    v_mfma_f32_16x16x32_bf16 v[196:199], v[62:65], v[164:167], v[196:199]
    s_waitcnt lgkmcnt(6)
    v_mfma_f32_16x16x32_bf16 v[184:187], v[66:69], v[168:171], v[184:187]
    ds_read_b64_tr_b16 v[62:63], v10 offset:12288
    ds_read_b64_tr_b16 v[64:65], v10 offset:14336
    v_mfma_f32_16x16x32_bf16 v[188:191], v[66:69], v[172:175], v[188:191]
    s_setprio 2
    s_waitcnt lgkmcnt(6)
    v_mfma_f32_16x16x32_bf16 v[192:195], v[50:53], v[168:171], v[192:195]
    ds_read_b64_tr_b16 v[66:67], v12 offset:12288
    ds_read_b64_tr_b16 v[68:69], v12 offset:14336
    v_mfma_f32_16x16x32_bf16 v[196:199], v[50:53], v[172:175], v[196:199]
    s_waitcnt lgkmcnt(6)
    v_mfma_f32_16x16x32_bf16 v[184:187], v[54:57], v[176:179], v[184:187]
    ds_read_b64_tr_b16 v[50:51], v10 offset:16384
    ds_read_b64_tr_b16 v[52:53], v10 offset:18432
    v_mfma_f32_16x16x32_bf16 v[188:191], v[54:57], v[180:183], v[188:191]
    s_waitcnt lgkmcnt(6)
    v_mfma_f32_16x16x32_bf16 v[192:195], v[58:61], v[176:179], v[192:195]
    ds_read_b64_tr_b16 v[54:55], v12 offset:16384
    ds_read_b64_tr_b16 v[56:57], v12 offset:18432
    v_mfma_f32_16x16x32_bf16 v[196:199], v[58:61], v[180:183], v[196:199]
    s_setprio 1
    s_waitcnt lgkmcnt(6)
    v_mfma_f32_16x16x32_bf16 v[200:203], v[62:65], v[112:115], 0
    ds_read_b64_tr_b16 v[58:59], v10 offset:20480
    ds_read_b64_tr_b16 v[60:61], v10 offset:22528
    v_mfma_f32_16x16x32_bf16 v[204:207], v[62:65], v[116:119], 0
    s_waitcnt lgkmcnt(6)
    v_mfma_f32_16x16x32_bf16 v[208:211], v[66:69], v[112:115], 0
    ds_read_b64_tr_b16 v[62:63], v12 offset:20480
    ds_read_b64_tr_b16 v[64:65], v12 offset:22528
    v_mfma_f32_16x16x32_bf16 v[212:215], v[66:69], v[116:119], 0
    s_waitcnt lgkmcnt(6)
    v_mfma_f32_16x16x32_bf16 v[200:203], v[50:53], v[120:123], v[200:203]
    ds_read_b64_tr_b16 v[66:67], v10 offset:24576
    ds_read_b64_tr_b16 v[68:69], v10 offset:26624
    v_cvt_pk_bf16_f32 v216, v184, v185
    v_cvt_pk_bf16_f32 v217, v186, v187
    v_mfma_f32_16x16x32_bf16 v[204:207], v[50:53], v[124:127], v[204:207]
    v_cvt_pk_bf16_f32 v218, v188, v189
    v_cvt_pk_bf16_f32 v219, v190, v191
    s_setprio 0
    s_waitcnt lgkmcnt(6)
    v_mfma_f32_16x16x32_bf16 v[208:211], v[54:57], v[120:123], v[208:211]
    ds_read_b64_tr_b16 v[50:51], v12 offset:24576
    ds_read_b64_tr_b16 v[52:53], v12 offset:26624
    s_mov_b32 s38, 1572864
    buffer_store_dwordx4 v[216:219], v20, s[16:19], s38 offen sc1
    v_mfma_f32_16x16x32_bf16 v[212:215], v[54:57], v[124:127], v[212:215]
    v_cvt_pk_bf16_f32 v220, v192, v193
    v_cvt_pk_bf16_f32 v221, v194, v195
    s_waitcnt lgkmcnt(6)
    v_mfma_f32_16x16x32_bf16 v[200:203], v[58:61], v[128:131], v[200:203]
    ds_read_b64_tr_b16 v[54:55], v10 offset:28672
    ds_read_b64_tr_b16 v[56:57], v10 offset:30720
    v_cvt_pk_bf16_f32 v222, v196, v197
    v_mfma_f32_16x16x32_bf16 v[204:207], v[58:61], v[132:135], v[204:207]
    v_cvt_pk_bf16_f32 v223, v198, v199
    s_mov_b32 s38, 1638400
    buffer_store_dwordx4 v[220:223], v20, s[16:19], s38 offen sc1
    s_waitcnt lgkmcnt(6)
    v_mfma_f32_16x16x32_bf16 v[208:211], v[62:65], v[128:131], v[208:211]
    ds_read_b64_tr_b16 v[58:59], v12 offset:28672
    ds_read_b64_tr_b16 v[60:61], v12 offset:30720
    v_mfma_f32_16x16x32_bf16 v[212:215], v[62:65], v[132:135], v[212:215]
    s_waitcnt vmcnt(7)
    s_barrier
    s_setprio 3
    s_waitcnt lgkmcnt(6)
    v_mfma_f32_16x16x32_bf16 v[200:203], v[66:69], v[136:139], v[200:203]
    ds_read_b64_tr_b16 v[62:63], v10 offset:32768
    ds_read_b64_tr_b16 v[64:65], v10 offset:34816
    v_mfma_f32_16x16x32_bf16 v[204:207], v[66:69], v[140:143], v[204:207]
    s_waitcnt lgkmcnt(6)
    v_mfma_f32_16x16x32_bf16 v[208:211], v[50:53], v[136:139], v[208:211]
    ds_read_b64_tr_b16 v[66:67], v12 offset:32768
    ds_read_b64_tr_b16 v[68:69], v12 offset:34816
    v_mfma_f32_16x16x32_bf16 v[212:215], v[50:53], v[140:143], v[212:215]
    s_waitcnt lgkmcnt(6)
    v_mfma_f32_16x16x32_bf16 v[200:203], v[54:57], v[144:147], v[200:203]
    ds_read_b64_tr_b16 v[50:51], v10 offset:36864
    ds_read_b64_tr_b16 v[52:53], v10 offset:38912
    v_mfma_f32_16x16x32_bf16 v[204:207], v[54:57], v[148:151], v[204:207]
    s_setprio 2
    s_waitcnt lgkmcnt(6)
    v_mfma_f32_16x16x32_bf16 v[208:211], v[58:61], v[144:147], v[208:211]
    ds_read_b64_tr_b16 v[54:55], v12 offset:36864
    ds_read_b64_tr_b16 v[56:57], v12 offset:38912
    v_mfma_f32_16x16x32_bf16 v[212:215], v[58:61], v[148:151], v[212:215]
    s_waitcnt lgkmcnt(6)
    v_mfma_f32_16x16x32_bf16 v[200:203], v[62:65], v[152:155], v[200:203]
    ds_read_b64_tr_b16 v[58:59], v10 offset:40960
    ds_read_b64_tr_b16 v[60:61], v10 offset:43008
    v_mfma_f32_16x16x32_bf16 v[204:207], v[62:65], v[156:159], v[204:207]
    s_waitcnt lgkmcnt(6)
    v_mfma_f32_16x16x32_bf16 v[208:211], v[66:69], v[152:155], v[208:211]
    ds_read_b64_tr_b16 v[62:63], v12 offset:40960
    ds_read_b64_tr_b16 v[64:65], v12 offset:43008
    v_mfma_f32_16x16x32_bf16 v[212:215], v[66:69], v[156:159], v[212:215]
    s_setprio 1
    s_waitcnt lgkmcnt(6)
    v_mfma_f32_16x16x32_bf16 v[200:203], v[50:53], v[160:163], v[200:203]
    ds_read_b64_tr_b16 v[66:67], v10 offset:45056
    ds_read_b64_tr_b16 v[68:69], v10 offset:47104
    v_mfma_f32_16x16x32_bf16 v[204:207], v[50:53], v[164:167], v[204:207]
    s_waitcnt lgkmcnt(6)
    v_mfma_f32_16x16x32_bf16 v[208:211], v[54:57], v[160:163], v[208:211]
    ds_read_b64_tr_b16 v[50:51], v12 offset:45056
    ds_read_b64_tr_b16 v[52:53], v12 offset:47104
    v_mfma_f32_16x16x32_bf16 v[212:215], v[54:57], v[164:167], v[212:215]
    s_waitcnt lgkmcnt(6)
    v_mfma_f32_16x16x32_bf16 v[200:203], v[58:61], v[168:171], v[200:203]
    ds_read_b64_tr_b16 v[54:55], v9 offset:0
    ds_read_b64_tr_b16 v[56:57], v9 offset:2048
    v_mfma_f32_16x16x32_bf16 v[204:207], v[58:61], v[172:175], v[204:207]
    s_setprio 0
    s_waitcnt lgkmcnt(6)
    v_mfma_f32_16x16x32_bf16 v[208:211], v[62:65], v[168:171], v[208:211]
    ds_read_b64_tr_b16 v[58:59], v11 offset:0
    ds_read_b64_tr_b16 v[60:61], v11 offset:2048
    v_mfma_f32_16x16x32_bf16 v[212:215], v[62:65], v[172:175], v[212:215]
    s_waitcnt lgkmcnt(6)
    v_mfma_f32_16x16x32_bf16 v[200:203], v[66:69], v[176:179], v[200:203]
    ds_read_b64_tr_b16 v[62:63], v9 offset:4096
    ds_read_b64_tr_b16 v[64:65], v9 offset:6144
    v_mfma_f32_16x16x32_bf16 v[204:207], v[66:69], v[180:183], v[204:207]
    s_waitcnt lgkmcnt(6)
    v_mfma_f32_16x16x32_bf16 v[208:211], v[50:53], v[176:179], v[208:211]
    ds_read_b64_tr_b16 v[66:67], v11 offset:4096
    ds_read_b64_tr_b16 v[68:69], v11 offset:6144
    v_mfma_f32_16x16x32_bf16 v[212:215], v[50:53], v[180:183], v[212:215]
    s_waitcnt vmcnt(4)
    s_barrier
    s_setprio 3
    s_waitcnt lgkmcnt(6)
    v_mfma_f32_16x16x32_bf16 v[184:187], v[54:57], v[112:115], 0
    ds_read_b64_tr_b16 v[50:51], v9 offset:8192
    ds_read_b64_tr_b16 v[52:53], v9 offset:10240
    v_mfma_f32_16x16x32_bf16 v[188:191], v[54:57], v[116:119], 0
    s_waitcnt lgkmcnt(6)
    v_mfma_f32_16x16x32_bf16 v[192:195], v[58:61], v[112:115], 0
    ds_read_b64_tr_b16 v[54:55], v11 offset:8192
    ds_read_b64_tr_b16 v[56:57], v11 offset:10240
    v_mfma_f32_16x16x32_bf16 v[196:199], v[58:61], v[116:119], 0
    s_waitcnt lgkmcnt(6)
    v_mfma_f32_16x16x32_bf16 v[184:187], v[62:65], v[120:123], v[184:187]
    ds_read_b64_tr_b16 v[58:59], v9 offset:12288
    ds_read_b64_tr_b16 v[60:61], v9 offset:14336
    v_cvt_pk_bf16_f32 v224, v200, v201
    v_mfma_f32_16x16x32_bf16 v[188:191], v[62:65], v[124:127], v[188:191]
    v_cvt_pk_bf16_f32 v225, v202, v203
    s_setprio 2
    s_waitcnt lgkmcnt(6)
    v_mfma_f32_16x16x32_bf16 v[192:195], v[66:69], v[120:123], v[192:195]
    ds_read_b64_tr_b16 v[62:63], v11 offset:12288
    ds_read_b64_tr_b16 v[64:65], v11 offset:14336
    v_mfma_f32_16x16x32_bf16 v[196:199], v[66:69], v[124:127], v[196:199]
    v_cvt_pk_bf16_f32 v226, v204, v205
    s_waitcnt lgkmcnt(6)
    v_mfma_f32_16x16x32_bf16 v[184:187], v[50:53], v[128:131], v[184:187]
    ds_read_b64_tr_b16 v[66:67], v9 offset:16384
    ds_read_b64_tr_b16 v[68:69], v9 offset:18432
    v_mfma_f32_16x16x32_bf16 v[188:191], v[50:53], v[132:135], v[188:191]
    v_cvt_pk_bf16_f32 v227, v206, v207
    s_waitcnt lgkmcnt(6)
    v_mfma_f32_16x16x32_bf16 v[192:195], v[54:57], v[128:131], v[192:195]
    ds_read_b64_tr_b16 v[50:51], v11 offset:16384
    ds_read_b64_tr_b16 v[52:53], v11 offset:18432
    v_mfma_f32_16x16x32_bf16 v[196:199], v[54:57], v[132:135], v[196:199]
    s_mov_b32 s38, 1835008
    buffer_store_dwordx4 v[224:227], v20, s[16:19], s38 offen sc1
    s_setprio 1
    s_waitcnt lgkmcnt(6)
    v_mfma_f32_16x16x32_bf16 v[184:187], v[58:61], v[136:139], v[184:187]
    ds_read_b64_tr_b16 v[54:55], v9 offset:20480
    ds_read_b64_tr_b16 v[56:57], v9 offset:22528
    v_mfma_f32_16x16x32_bf16 v[188:191], v[58:61], v[140:143], v[188:191]
    v_cvt_pk_bf16_f32 v228, v208, v209
    s_waitcnt lgkmcnt(6)
    v_mfma_f32_16x16x32_bf16 v[192:195], v[62:65], v[136:139], v[192:195]
    ds_read_b64_tr_b16 v[58:59], v11 offset:20480
    ds_read_b64_tr_b16 v[60:61], v11 offset:22528
    v_mfma_f32_16x16x32_bf16 v[196:199], v[62:65], v[140:143], v[196:199]
    v_cvt_pk_bf16_f32 v229, v210, v211
    s_waitcnt lgkmcnt(6)
    v_mfma_f32_16x16x32_bf16 v[184:187], v[66:69], v[144:147], v[184:187]
    ds_read_b64_tr_b16 v[62:63], v4 offset:0
    ds_read_b64_tr_b16 v[64:65], v4 offset:2048
    v_mfma_f32_16x16x32_bf16 v[188:191], v[66:69], v[148:151], v[188:191]
    v_cvt_pk_bf16_f32 v230, v212, v213
    s_setprio 0
    s_waitcnt lgkmcnt(6)
    v_mfma_f32_16x16x32_bf16 v[192:195], v[50:53], v[144:147], v[192:195]
    ds_read_b64_tr_b16 v[66:67], v5 offset:0
    ds_read_b64_tr_b16 v[68:69], v5 offset:2048
    v_mfma_f32_16x16x32_bf16 v[196:199], v[50:53], v[148:151], v[196:199]
    v_cvt_pk_bf16_f32 v231, v214, v215
    s_waitcnt lgkmcnt(6)
    v_mfma_f32_16x16x32_bf16 v[184:187], v[54:57], v[152:155], v[184:187]
    ds_read_b64_tr_b16 v[50:51], v4 offset:4096
    ds_read_b64_tr_b16 v[52:53], v4 offset:6144
    v_mfma_f32_16x16x32_bf16 v[188:191], v[54:57], v[156:159], v[188:191]
    s_mov_b32 s38, 1900544
    buffer_store_dwordx4 v[228:231], v20, s[16:19], s38 offen sc1
    s_waitcnt lgkmcnt(6)
    v_mfma_f32_16x16x32_bf16 v[192:195], v[58:61], v[152:155], v[192:195]
    ds_read_b64_tr_b16 v[54:55], v5 offset:4096
    ds_read_b64_tr_b16 v[56:57], v5 offset:6144
    v_mfma_f32_16x16x32_bf16 v[196:199], v[58:61], v[156:159], v[196:199]
    s_barrier
    s_setprio 3
    s_waitcnt lgkmcnt(6)
    v_mfma_f32_16x16x32_bf16 v[184:187], v[62:65], v[160:163], v[184:187]
    ds_read_b64_tr_b16 v[58:59], v4 offset:8192
    ds_read_b64_tr_b16 v[60:61], v4 offset:10240
    v_mfma_f32_16x16x32_bf16 v[188:191], v[62:65], v[164:167], v[188:191]
    s_waitcnt lgkmcnt(6)
    v_mfma_f32_16x16x32_bf16 v[192:195], v[66:69], v[160:163], v[192:195]
    ds_read_b64_tr_b16 v[62:63], v5 offset:8192
    ds_read_b64_tr_b16 v[64:65], v5 offset:10240
    v_mfma_f32_16x16x32_bf16 v[196:199], v[66:69], v[164:167], v[196:199]
    s_setprio 2
    s_waitcnt lgkmcnt(6)
    v_mfma_f32_16x16x32_bf16 v[184:187], v[50:53], v[168:171], v[184:187]
    v_mfma_f32_16x16x32_bf16 v[188:191], v[50:53], v[172:175], v[188:191]
    s_setprio 1
    s_waitcnt lgkmcnt(4)
    v_mfma_f32_16x16x32_bf16 v[192:195], v[54:57], v[168:171], v[192:195]
    v_mfma_f32_16x16x32_bf16 v[196:199], v[54:57], v[172:175], v[196:199]
    s_waitcnt lgkmcnt(2)
    v_mfma_f32_16x16x32_bf16 v[184:187], v[58:61], v[176:179], v[184:187]
    v_mfma_f32_16x16x32_bf16 v[188:191], v[58:61], v[180:183], v[188:191]
    s_setprio 0
    s_waitcnt lgkmcnt(0)
    v_mfma_f32_16x16x32_bf16 v[192:195], v[62:65], v[176:179], v[192:195]
    v_mfma_f32_16x16x32_bf16 v[196:199], v[62:65], v[180:183], v[196:199]
    s_nop 7
    v_cvt_pk_bf16_f32 v216, v184, v185
    v_cvt_pk_bf16_f32 v217, v186, v187
    v_cvt_pk_bf16_f32 v218, v188, v189
    v_cvt_pk_bf16_f32 v219, v190, v191
    s_mov_b32 s38, 2097152
    buffer_store_dwordx4 v[216:219], v20, s[16:19], s38 offen sc1
    v_cvt_pk_bf16_f32 v220, v192, v193
    v_cvt_pk_bf16_f32 v221, v194, v195
    v_cvt_pk_bf16_f32 v222, v196, v197
    v_cvt_pk_bf16_f32 v223, v198, v199
    s_mov_b32 s38, 2162688
    buffer_store_dwordx4 v[220:223], v20, s[16:19], s38 offen sc1
K1_END:
    s_endpgm
.globl ssm_kernel
.p2align 8
.type ssm_kernel,@function
ssm_kernel:
    s_cmp_ge_u32 s2, 144
    s_cbranch_scc1 K2_END
    s_load_dwordx2 s[16:17], s[0:1], 128
    s_load_dwordx4 s[52:55], s[0:1], 104
    v_lshrrev_b32 v5, 6, v0
    v_and_b32 v1, 63, v0
    v_readfirstlane_b32 s20, v5
    v_lshrrev_b32 v2, 4, v1
    v_and_b32 v3, 15, v1
    s_and_b32 s23, s2, 7
    s_mul_i32 s23, s23, 18
    s_lshr_b32 s25, s2, 3
    s_add_u32 s23, s23, s25
    s_mov_b32 s28, 0xffff0000
    s_mov_b32 s18, 268435456
    s_mov_b32 s19, 0x00020000
    s_cmp_ge_u32 s20, 8
    s_cbranch_scc1 K2_LOADER
    s_setprio 2
    s_lshr_b32 s21, s20, 1
    s_and_b32 s22, s20, 1
    s_lshl_b32 s24, s23, 2
    s_add_u32 s24, s24, s21
    s_mul_i32 s29, s21, 22272
    v_and_b32 v19, 127, v0
    v_lshlrev_b32 v4, 4, v19
    v_lshlrev_b32 v5, 2, v5
    v_add_u32 v5, 160768, v5
    v_mov_b32 v100, 0
    v_mov_b32 v101, 0
    v_mov_b32 v102, 0
    v_mov_b32 v103, 0
    ds_write_b32 v5, v100
    s_waitcnt lgkmcnt(0)
    s_lshl_b32 s25, s24, 11
    s_add_u32 s25, s25, 42467328
    buffer_load_dwordx4 v[92:95], v4, s[16:19], s25 offen
    s_lshl_b32 s25, s24, 12
    s_add_u32 s25, s25, 40108032
    s_sub_u32 s26, s25, 8
    buffer_load_dwordx4 v[118:121], v4, s[16:19], s25 offen offset:0
    buffer_load_dwordx2 v[116:117], v4, s[16:19], s26 offen offset:0
    buffer_load_dwordx4 v[124:127], v4, s[16:19], s25 offen offset:2048
    buffer_load_dwordx2 v[122:123], v4, s[16:19], s26 offen offset:2048
    s_barrier
    v_add_u32 v4, s29, v4
    v_cmp_gt_u32 vcc, 24, v19
    s_and_saveexec_b64 s[62:63], vcc
    s_cbranch_execz K2_Z1
    ds_write_b128 v4, v[100:103] offset:0
    ds_write_b128 v4, v[100:103] offset:4512
    ds_write_b128 v4, v[100:103] offset:9024
    ds_write_b128 v4, v[100:103] offset:13536
    v_cmp_gt_u32 vcc, 8, v19
    s_and_b64 exec, exec, vcc
    ds_write_b128 v4, v[100:103] offset:22144
K2_Z1:
    s_mov_b64 exec, s[62:63]
    v_lshlrev_b32 v20, 3, v19
    v_sub_u32 v20, 1023, v20
    v_cvt_f32_u32 v21, v20
    v_add_u32 v20, 0x4280, v20
    v_add_u32 v24, -1, v20
    v_lshl_or_b32 v20, v24, 16, v20
    v_cmp_le_u32 vcc, 112, v19
    v_add_f32 v22, 0x44800000, v21
    v_add_f32 v23, 0x447fc000, v21
    v_cvt_pk_bf16_f32 v6, v22, v23
    v_add_f32 v22, 0x80000000, v21
    v_add_f32 v23, 0xbf800000, v21
    v_cvt_pk_bf16_f32 v22, v22, v23
    v_subrev_u32 v23, 0x0, v20
    v_cndmask_b32 v10, v22, v23, vcc
    v_add_f32 v22, 0x447f8000, v21
    v_add_f32 v23, 0x447f4000, v21
    v_cvt_pk_bf16_f32 v7, v22, v23
    v_add_f32 v22, 0xc0000000, v21
    v_add_f32 v23, 0xc0400000, v21
    v_cvt_pk_bf16_f32 v22, v22, v23
    v_subrev_u32 v23, 0x20002, v20
    v_cndmask_b32 v11, v22, v23, vcc
    v_add_f32 v22, 0x447f0000, v21
    v_add_f32 v23, 0x447ec000, v21
    v_cvt_pk_bf16_f32 v8, v22, v23
    v_add_f32 v22, 0xc0800000, v21
    v_add_f32 v23, 0xc0a00000, v21
    v_cvt_pk_bf16_f32 v22, v22, v23
    v_subrev_u32 v23, 0x40004, v20
    v_cndmask_b32 v12, v22, v23, vcc
    v_add_f32 v22, 0x447e8000, v21
    v_add_f32 v23, 0x447e4000, v21
    v_cvt_pk_bf16_f32 v9, v22, v23
    v_add_f32 v22, 0xc0c00000, v21
    v_add_f32 v23, 0xc0e00000, v21
    v_cvt_pk_bf16_f32 v22, v22, v23
    v_subrev_u32 v23, 0x60006, v20
    v_cndmask_b32 v13, v22, v23, vcc
    v_add_u32 v20, 16, v3
    v_lshlrev_b32 v21, 4, v2
    s_cmp_eq_u32 s22, 1
    s_mov_b32 s64, 0x130003
    s_cselect_b32 s64, 0x6050a04, s64
    s_mov_b32 s65, 0x6010402
    s_cselect_b32 s65, 0x8000701, s65
    v_lshrrev_b64 v[22:23], v21, s[64:65]
    v_and_b32 v23, 3, v22
    v_bfe_u32 v22, v22, 2, 10
    v_lshl_add_u32 v14, v3, v23, v22
    v_lshl_add_u32 v16, v20, v23, v22
    s_mov_b32 s64, 0x170007
    s_cselect_b32 s64, 0xa040a04, s64
    s_mov_b32 s65, 0xa040406
    s_cselect_b32 s65, 0xa040a04, s65
    v_lshrrev_b64 v[22:23], v21, s[64:65]
    v_and_b32 v23, 3, v22
    v_bfe_u32 v22, v22, 2, 10
    v_lshl_add_u32 v24, v3, v23, v22
    v_lshl_or_b32 v14, v24, 16, v14
    v_lshl_add_u32 v24, v20, v23, v22
    v_lshl_or_b32 v16, v24, 16, v16
    s_mov_b32 s64, 0x1b000b
    s_cselect_b32 s64, 0xa040a04, s64
    s_mov_b32 s65, 0x880040a
    s_cselect_b32 s65, 0x9800705, s65
    v_lshrrev_b64 v[22:23], v21, s[64:65]
    v_and_b32 v23, 3, v22
    v_bfe_u32 v22, v22, 2, 10
    v_lshl_add_u32 v15, v3, v23, v22
    v_lshl_add_u32 v17, v20, v23, v22
    s_mov_b32 s64, 0x1f000f
    s_cselect_b32 s64, 0xa040a04, s64
    s_mov_b32 s65, 0x900040e
    s_cselect_b32 s65, 0xa000a04, s65
    v_lshrrev_b64 v[22:23], v21, s[64:65]
    v_and_b32 v23, 3, v22
    v_bfe_u32 v22, v22, 2, 10
    v_lshl_add_u32 v24, v3, v23, v22
    v_lshl_or_b32 v15, v24, 16, v15
    v_lshl_add_u32 v24, v20, v23, v22
    v_lshl_or_b32 v17, v24, 16, v17
    v_cmp_eq_u32 s[60:61], 0, v19
    s_lshl_b32 s25, s20, 13
    s_add_u32 s25, s25, 89088
    v_lshlrev_b32 v22, 4, v1
    v_add_u32 v30, s25, v22
    s_mul_i32 s25, s21, 1536
    s_add_u32 s73, s25, 154624
    s_sub_u32 s74, s73, 34048
    v_mad_u32_u16 v108, v14, 2, s73 op_sel:[0,0,0,0]
    v_mad_u32_u16 v109, v14, 2, s73 op_sel:[1,0,0,0]
    v_mad_u32_u16 v110, v15, 2, s73 op_sel:[0,0,0,0]
    v_mad_u32_u16 v111, v15, 2, s73 op_sel:[1,0,0,0]
    v_mad_u32_u16 v112, v16, 2, s73 op_sel:[0,0,0,0]
    v_mad_u32_u16 v113, v16, 2, s73 op_sel:[1,0,0,0]
    v_mad_u32_u16 v114, v17, 2, s73 op_sel:[0,0,0,0]
    v_mad_u32_u16 v115, v17, 2, s73 op_sel:[1,0,0,0]
    v_mad_u32_u16 v68, v6, 2, s74 op_sel:[0,0,0,0]
    v_mad_u32_u16 v69, v6, 2, s74 op_sel:[1,0,0,0]
    v_mad_u32_u16 v70, v7, 2, s74 op_sel:[0,0,0,0]
    v_mad_u32_u16 v71, v7, 2, s74 op_sel:[1,0,0,0]
    v_mad_u32_u16 v72, v8, 2, s74 op_sel:[0,0,0,0]
    v_mad_u32_u16 v73, v8, 2, s74 op_sel:[1,0,0,0]
    v_mad_u32_u16 v74, v9, 2, s74 op_sel:[0,0,0,0]
    v_mad_u32_u16 v75, v9, 2, s74 op_sel:[1,0,0,0]
    v_mad_u32_u16 v76, v10, 2, s74 op_sel:[0,0,0,0]
    v_mad_u32_u16 v77, v10, 2, s74 op_sel:[1,0,0,0]
    v_mad_u32_u16 v78, v11, 2, s74 op_sel:[0,0,0,0]
    v_mad_u32_u16 v79, v11, 2, s74 op_sel:[1,0,0,0]
    v_mad_u32_u16 v80, v12, 2, s74 op_sel:[0,0,0,0]
    v_mad_u32_u16 v81, v12, 2, s74 op_sel:[1,0,0,0]
    v_mad_u32_u16 v82, v13, 2, s74 op_sel:[0,0,0,0]
    v_mad_u32_u16 v83, v13, 2, s74 op_sel:[1,0,0,0]
    s_waitcnt vmcnt(4)
    ds_write_b16 v108, v92
    ds_write_b16_d16_hi v109, v92
    ds_write_b16 v110, v93
    ds_write_b16_d16_hi v111, v93
    ds_write_b16 v112, v94
    ds_write_b16_d16_hi v113, v94
    ds_write_b16 v114, v95
    ds_write_b16_d16_hi v115, v95
    v_mov_b32 v34, 1
    ds_write_b32 v5, v34
    v_xor_b32 v35, 4, v5
K2_S_1:
    ds_read_b32 v34, v35
    s_waitcnt lgkmcnt(0)
    v_readfirstlane_b32 s75, v34
    s_cmp_ge_u32 s75, 1
    s_cbranch_scc0 K2_S_1
    ds_read_u16 v84, v68
    ds_read_u16 v85, v69
    ds_read_u16 v86, v70
    ds_read_u16 v87, v71
    ds_read_u16 v88, v72
    ds_read_u16 v89, v73
    ds_read_u16 v90, v74
    ds_read_u16 v91, v75
    ds_read_u16 v92, v76
    ds_read_u16 v93, v77
    ds_read_u16 v94, v78
    ds_read_u16 v95, v79
    ds_read_u16 v96, v80
    ds_read_u16 v97, v81
    ds_read_u16 v98, v82
    ds_read_u16 v99, v83
    s_waitcnt vmcnt(0)
    v_cndmask_b32 v116, v116, 0, s[60:61]
    v_cndmask_b32 v117, v117, 0, s[60:61]
    ds_write_b128 v4, v[118:121] offset:13920
    v_alignbit_b32 v36, v117, v116, 16
    v_alignbit_b32 v37, v118, v117, 16
    v_alignbit_b32 v38, v119, v118, 16
    v_alignbit_b32 v39, v120, v119, 16
    v_alignbit_b32 v40, v118, v117, 16
    v_alignbit_b32 v41, v119, v118, 16
    v_alignbit_b32 v42, v120, v119, 16
    v_alignbit_b32 v43, v121, v120, 16
    v_mov_b32 v44, v117
    v_mov_b32 v45, v118
    v_mov_b32 v46, v119
    v_mov_b32 v47, v120
    ds_write_b128 v4, v[36:39] offset:384
    ds_write_b128 v4, v[40:43] offset:9408
    ds_write_b128 v4, v[44:47] offset:4896
    ds_write_b128 v4, v[124:127] offset:15968
    v_alignbit_b32 v52, v123, v122, 16
    v_alignbit_b32 v53, v124, v123, 16
    v_alignbit_b32 v54, v125, v124, 16
    v_alignbit_b32 v55, v126, v125, 16
    v_alignbit_b32 v56, v124, v123, 16
    v_alignbit_b32 v57, v125, v124, 16
    v_alignbit_b32 v58, v126, v125, 16
    v_alignbit_b32 v59, v127, v126, 16
    v_mov_b32 v60, v123
    v_mov_b32 v61, v124
    v_mov_b32 v62, v125
    v_mov_b32 v63, v126
    ds_write_b128 v4, v[52:55] offset:2432
    ds_write_b128 v4, v[56:59] offset:11456
    ds_write_b128 v4, v[60:63] offset:6944
    v_and_b32 v108, 3, v3
    v_mul_u32_u24 v108, 4512, v108
    v_lshrrev_b32 v109, 2, v3
    v_lshl_add_u32 v108, v109, 7, v108
    v_lshl_add_u32 v108, v2, 4, v108
    s_lshl_b32 s25, s22, 8
    s_add_u32 s25, s25, s29
    v_add_u32 v14, s25, v108
    v_lshlrev_b32 v108, 4, v2
    v_lshlrev_b32 v109, 3, v3
    v_sub_u32 v108, v108, v109
    s_add_u32 s25, s25, 18168
    v_add_u32 v15, s25, v108
    s_waitcnt lgkmcnt(15)
    v_lshl_or_b32 v100, v85, 16, v84
    v_lshl_or_b32 v101, v87, 16, v86
    v_lshl_or_b32 v102, v89, 16, v88
    v_lshl_or_b32 v103, v91, 16, v90
    ds_write_b128 v4, v[100:103] offset:18048
    s_waitcnt lgkmcnt(9)
    v_lshl_or_b32 v104, v93, 16, v92
    v_lshl_or_b32 v105, v95, 16, v94
    v_lshl_or_b32 v106, v97, 16, v96
    v_lshl_or_b32 v107, v99, 16, v98
    ds_write_b128 v4, v[104:107] offset:20096
    v_mov_b32 v34, 2
    ds_write_b32 v5, v34
    v_xor_b32 v35, 4, v5
K2_S_2:
    ds_read_b32 v34, v35
    s_waitcnt lgkmcnt(0)
    v_readfirstlane_b32 s75, v34
    s_cmp_ge_u32 s75, 2
    s_cbranch_scc0 K2_S_2
    ds_read_b128 v[18:21], v14 offset:0
    ds_read_b64 v[32:33], v15 offset:3584
    ds_read_b64 v[34:35], v15 offset:3592
    ds_read_b64 v[36:37], v15 offset:3072
    ds_read_b64 v[38:39], v15 offset:3080
    ds_read_b64 v[40:41], v15 offset:2560
    ds_read_b64 v[42:43], v15 offset:2568
    ds_read_b64 v[44:45], v15 offset:2048
    ds_read_b64 v[46:47], v15 offset:2056
    ds_read_b64 v[48:49], v15 offset:1536
    ds_read_b64 v[50:51], v15 offset:1544
    ds_read_b64 v[52:53], v15 offset:1024
    ds_read_b64 v[54:55], v15 offset:1032
    ds_read_b64 v[56:57], v15 offset:512
    ds_read_b64 v[58:59], v15 offset:520
    ds_read_b64 v[60:61], v15 offset:0
    ds_read_b64 v[62:63], v15 offset:8
    ds_read_b128 v[22:25], v14 offset:3584
    ds_read_b128 v[26:29], v14 offset:512
    ds_read_b128 v[6:9], v14 offset:3072
    ds_read_b128 v[10:13], v14 offset:1024
    ds_read_b64 v[64:65], v15 offset:3648
    ds_read_b64 v[66:67], v15 offset:3656
    ds_read_b64 v[68:69], v15 offset:3136
    ds_read_b64 v[70:71], v15 offset:3144
    s_waitcnt lgkmcnt(15)
    v_mfma_f32_16x16x32_bf16 v[96:99], v[18:21], v[32:35], 0
    v_mfma_f32_16x16x32_bf16 v[100:103], v[18:21], v[36:39], 0
    v_mfma_f32_16x16x32_bf16 v[104:107], v[18:21], v[40:43], 0
    v_mfma_f32_16x16x32_bf16 v[108:111], v[18:21], v[44:47], 0
    s_waitcnt lgkmcnt(14)
    v_mfma_f32_16x16x32_bf16 v[112:115], v[18:21], v[48:51], 0
    s_waitcnt lgkmcnt(12)
    v_mfma_f32_16x16x32_bf16 v[116:119], v[18:21], v[52:55], 0
    s_waitcnt lgkmcnt(10)
    v_mfma_f32_16x16x32_bf16 v[120:123], v[18:21], v[56:59], 0
    s_waitcnt lgkmcnt(8)
    v_mfma_f32_16x16x32_bf16 v[124:127], v[18:21], v[60:63], 0
    ds_read_b128 v[18:21], v14 offset:2560
    s_waitcnt lgkmcnt(8)
    v_mfma_f32_16x16x32_bf16 v[124:127], v[22:25], v[32:35], v[124:127]
    ds_read_b128 v[22:25], v14 offset:1536
    ds_read_b64 v[72:73], v15 offset:2624
    ds_read_b64 v[74:75], v15 offset:2632
    ds_read_b64 v[76:77], v15 offset:2112
    ds_read_b64 v[78:79], v15 offset:2120
    s_waitcnt lgkmcnt(12)
    v_mfma_f32_16x16x32_bf16 v[100:103], v[26:29], v[32:35], v[100:103]
    v_mfma_f32_16x16x32_bf16 v[104:107], v[26:29], v[36:39], v[104:107]
    v_mfma_f32_16x16x32_bf16 v[108:111], v[26:29], v[40:43], v[108:111]
    v_mfma_f32_16x16x32_bf16 v[112:115], v[26:29], v[44:47], v[112:115]
    v_mfma_f32_16x16x32_bf16 v[116:119], v[26:29], v[48:51], v[116:119]
    v_mfma_f32_16x16x32_bf16 v[120:123], v[26:29], v[52:55], v[120:123]
    v_mfma_f32_16x16x32_bf16 v[124:127], v[26:29], v[56:59], v[124:127]
    ds_read_b128 v[26:29], v14 offset:2048
    s_waitcnt lgkmcnt(12)
    v_mfma_f32_16x16x32_bf16 v[120:123], v[6:9], v[32:35], v[120:123]
    v_mfma_f32_16x16x32_bf16 v[124:127], v[6:9], v[36:39], v[124:127]
    ds_read_b128 v[6:9], v14 offset:64
    ds_read_b64 v[80:81], v15 offset:1600
    ds_read_b64 v[82:83], v15 offset:1608
    ds_read_b64 v[84:85], v15 offset:1088
    ds_read_b64 v[86:87], v15 offset:1096
    s_waitcnt lgkmcnt(15)
    v_mfma_f32_16x16x32_bf16 v[104:107], v[10:13], v[32:35], v[104:107]
    v_mfma_f32_16x16x32_bf16 v[108:111], v[10:13], v[36:39], v[108:111]
    v_mfma_f32_16x16x32_bf16 v[112:115], v[10:13], v[40:43], v[112:115]
    v_mfma_f32_16x16x32_bf16 v[116:119], v[10:13], v[44:47], v[116:119]
    v_mfma_f32_16x16x32_bf16 v[120:123], v[10:13], v[48:51], v[120:123]
    v_mfma_f32_16x16x32_bf16 v[124:127], v[10:13], v[52:55], v[124:127]
    ds_read_b128 v[10:13], v14 offset:3648
    s_waitcnt lgkmcnt(12)
    v_mfma_f32_16x16x32_bf16 v[116:119], v[18:21], v[32:35], v[116:119]
    v_mfma_f32_16x16x32_bf16 v[120:123], v[18:21], v[36:39], v[120:123]
    v_mfma_f32_16x16x32_bf16 v[124:127], v[18:21], v[40:43], v[124:127]
    ds_read_b128 v[18:21], v14 offset:576
    ds_read_b64 v[88:89], v15 offset:576
    ds_read_b64 v[90:91], v15 offset:584
    ds_read_b64 v[92:93], v15 offset:64
    ds_read_b64 v[94:95], v15 offset:72
    s_waitcnt lgkmcnt(15)
    v_mfma_f32_16x16x32_bf16 v[108:111], v[22:25], v[32:35], v[108:111]
    v_mfma_f32_16x16x32_bf16 v[112:115], v[22:25], v[36:39], v[112:115]
    v_mfma_f32_16x16x32_bf16 v[116:119], v[22:25], v[40:43], v[116:119]
    v_mfma_f32_16x16x32_bf16 v[120:123], v[22:25], v[44:47], v[120:123]
    v_mfma_f32_16x16x32_bf16 v[124:127], v[22:25], v[48:51], v[124:127]
    ds_read_b128 v[22:25], v14 offset:3136
    s_waitcnt lgkmcnt(12)
    v_mfma_f32_16x16x32_bf16 v[112:115], v[26:29], v[32:35], v[112:115]
    v_mfma_f32_16x16x32_bf16 v[116:119], v[26:29], v[36:39], v[116:119]
    v_mfma_f32_16x16x32_bf16 v[120:123], v[26:29], v[40:43], v[120:123]
    v_mfma_f32_16x16x32_bf16 v[124:127], v[26:29], v[44:47], v[124:127]
    ds_read_b128 v[26:29], v14 offset:1088
    ds_read_b64 v[32:33], v15 offset:3712
    ds_read_b64 v[34:35], v15 offset:3720
    ds_read_b64 v[36:37], v15 offset:3200
    ds_read_b64 v[38:39], v15 offset:3208
    s_waitcnt lgkmcnt(15)
    v_mfma_f32_16x16x32_bf16 v[96:99], v[6:9], v[64:67], v[96:99]
    v_mfma_f32_16x16x32_bf16 v[100:103], v[6:9], v[68:71], v[100:103]
    v_mfma_f32_16x16x32_bf16 v[104:107], v[6:9], v[72:75], v[104:107]
    v_mfma_f32_16x16x32_bf16 v[108:111], v[6:9], v[76:79], v[108:111]
    s_waitcnt lgkmcnt(14)
    v_mfma_f32_16x16x32_bf16 v[112:115], v[6:9], v[80:83], v[112:115]
    s_waitcnt lgkmcnt(12)
    v_mfma_f32_16x16x32_bf16 v[116:119], v[6:9], v[84:87], v[116:119]
    s_waitcnt lgkmcnt(8)
    v_mfma_f32_16x16x32_bf16 v[120:123], v[6:9], v[88:91], v[120:123]
    s_waitcnt lgkmcnt(6)
    v_mfma_f32_16x16x32_bf16 v[124:127], v[6:9], v[92:95], v[124:127]
    ds_read_b128 v[6:9], v14 offset:2624
    v_mfma_f32_16x16x32_bf16 v[124:127], v[10:13], v[64:67], v[124:127]
    ds_read_b128 v[10:13], v14 offset:1600
    ds_read_b64 v[40:41], v15 offset:2688
    ds_read_b64 v[42:43], v15 offset:2696
    ds_read_b64 v[44:45], v15 offset:2176
    ds_read_b64 v[46:47], v15 offset:2184
    v_mfma_f32_16x16x32_bf16 v[100:103], v[18:21], v[64:67], v[100:103]
    v_mfma_f32_16x16x32_bf16 v[104:107], v[18:21], v[68:71], v[104:107]
    v_mfma_f32_16x16x32_bf16 v[108:111], v[18:21], v[72:75], v[108:111]
    v_mfma_f32_16x16x32_bf16 v[112:115], v[18:21], v[76:79], v[112:115]
    v_mfma_f32_16x16x32_bf16 v[116:119], v[18:21], v[80:83], v[116:119]
    v_mfma_f32_16x16x32_bf16 v[120:123], v[18:21], v[84:87], v[120:123]
    v_mfma_f32_16x16x32_bf16 v[124:127], v[18:21], v[88:91], v[124:127]
    ds_read_b128 v[18:21], v14 offset:2112
    s_waitcnt lgkmcnt(12)
    v_mfma_f32_16x16x32_bf16 v[120:123], v[22:25], v[64:67], v[120:123]
    v_mfma_f32_16x16x32_bf16 v[124:127], v[22:25], v[68:71], v[124:127]
    ds_read_b128 v[22:25], v14 offset:128
    ds_read_b64 v[48:49], v15 offset:1664
    ds_read_b64 v[50:51], v15 offset:1672
    ds_read_b64 v[52:53], v15 offset:1152
    ds_read_b64 v[54:55], v15 offset:1160
    s_waitcnt lgkmcnt(15)
    v_mfma_f32_16x16x32_bf16 v[104:107], v[26:29], v[64:67], v[104:107]
    v_mfma_f32_16x16x32_bf16 v[108:111], v[26:29], v[68:71], v[108:111]
    v_mfma_f32_16x16x32_bf16 v[112:115], v[26:29], v[72:75], v[112:115]
    v_mfma_f32_16x16x32_bf16 v[116:119], v[26:29], v[76:79], v[116:119]
    v_mfma_f32_16x16x32_bf16 v[120:123], v[26:29], v[80:83], v[120:123]
    v_mfma_f32_16x16x32_bf16 v[124:127], v[26:29], v[84:87], v[124:127]
    ds_read_b128 v[26:29], v14 offset:3712
    s_waitcnt lgkmcnt(12)
    v_mfma_f32_16x16x32_bf16 v[116:119], v[6:9], v[64:67], v[116:119]
    v_mfma_f32_16x16x32_bf16 v[120:123], v[6:9], v[68:71], v[120:123]
    v_mfma_f32_16x16x32_bf16 v[124:127], v[6:9], v[72:75], v[124:127]
    ds_read_b128 v[6:9], v14 offset:640
    ds_read_b64 v[56:57], v15 offset:640
    ds_read_b64 v[58:59], v15 offset:648
    ds_read_b64 v[60:61], v15 offset:128
    ds_read_b64 v[62:63], v15 offset:136
    s_waitcnt lgkmcnt(15)
    v_mfma_f32_16x16x32_bf16 v[108:111], v[10:13], v[64:67], v[108:111]
    v_mfma_f32_16x16x32_bf16 v[112:115], v[10:13], v[68:71], v[112:115]
    v_mfma_f32_16x16x32_bf16 v[116:119], v[10:13], v[72:75], v[116:119]
    v_mfma_f32_16x16x32_bf16 v[120:123], v[10:13], v[76:79], v[120:123]
    v_mfma_f32_16x16x32_bf16 v[124:127], v[10:13], v[80:83], v[124:127]
    ds_read_b128 v[10:13], v14 offset:3200
    s_waitcnt lgkmcnt(12)
    v_mfma_f32_16x16x32_bf16 v[112:115], v[18:21], v[64:67], v[112:115]
    v_mfma_f32_16x16x32_bf16 v[116:119], v[18:21], v[68:71], v[116:119]
    v_mfma_f32_16x16x32_bf16 v[120:123], v[18:21], v[72:75], v[120:123]
    v_mfma_f32_16x16x32_bf16 v[124:127], v[18:21], v[76:79], v[124:127]
    ds_read_b128 v[18:21], v14 offset:1152
    ds_read_b64 v[64:65], v15 offset:3776
    ds_read_b64 v[66:67], v15 offset:3784
    ds_read_b64 v[68:69], v15 offset:3264
    ds_read_b64 v[70:71], v15 offset:3272
    s_waitcnt lgkmcnt(15)
    v_mfma_f32_16x16x32_bf16 v[96:99], v[22:25], v[32:35], v[96:99]
    v_mfma_f32_16x16x32_bf16 v[100:103], v[22:25], v[36:39], v[100:103]
    v_mfma_f32_16x16x32_bf16 v[104:107], v[22:25], v[40:43], v[104:107]
    v_mfma_f32_16x16x32_bf16 v[108:111], v[22:25], v[44:47], v[108:111]
    s_waitcnt lgkmcnt(14)
    v_mfma_f32_16x16x32_bf16 v[112:115], v[22:25], v[48:51], v[112:115]
    s_waitcnt lgkmcnt(12)
    v_mfma_f32_16x16x32_bf16 v[116:119], v[22:25], v[52:55], v[116:119]
    s_waitcnt lgkmcnt(8)
    v_mfma_f32_16x16x32_bf16 v[120:123], v[22:25], v[56:59], v[120:123]
    s_waitcnt lgkmcnt(6)
    v_mfma_f32_16x16x32_bf16 v[124:127], v[22:25], v[60:63], v[124:127]
    ds_read_b128 v[22:25], v14 offset:2688
    v_mfma_f32_16x16x32_bf16 v[124:127], v[26:29], v[32:35], v[124:127]
    ds_read_b128 v[26:29], v14 offset:1664
    ds_read_b64 v[72:73], v15 offset:2752
    ds_read_b64 v[74:75], v15 offset:2760
    ds_read_b64 v[76:77], v15 offset:2240
    ds_read_b64 v[78:79], v15 offset:2248
    v_mfma_f32_16x16x32_bf16 v[100:103], v[6:9], v[32:35], v[100:103]
    v_mfma_f32_16x16x32_bf16 v[104:107], v[6:9], v[36:39], v[104:107]
    v_mfma_f32_16x16x32_bf16 v[108:111], v[6:9], v[40:43], v[108:111]
    v_mfma_f32_16x16x32_bf16 v[112:115], v[6:9], v[44:47], v[112:115]
    v_mfma_f32_16x16x32_bf16 v[116:119], v[6:9], v[48:51], v[116:119]
    v_mfma_f32_16x16x32_bf16 v[120:123], v[6:9], v[52:55], v[120:123]
    v_mfma_f32_16x16x32_bf16 v[124:127], v[6:9], v[56:59], v[124:127]
    ds_read_b128 v[6:9], v14 offset:2176
    s_waitcnt lgkmcnt(12)
    v_mfma_f32_16x16x32_bf16 v[120:123], v[10:13], v[32:35], v[120:123]
    v_mfma_f32_16x16x32_bf16 v[124:127], v[10:13], v[36:39], v[124:127]
    ds_read_b128 v[10:13], v14 offset:192
    ds_read_b64 v[80:81], v15 offset:1728
    ds_read_b64 v[82:83], v15 offset:1736
    ds_read_b64 v[84:85], v15 offset:1216
    ds_read_b64 v[86:87], v15 offset:1224
    s_waitcnt lgkmcnt(15)
    v_mfma_f32_16x16x32_bf16 v[104:107], v[18:21], v[32:35], v[104:107]
    v_mfma_f32_16x16x32_bf16 v[108:111], v[18:21], v[36:39], v[108:111]
    v_mfma_f32_16x16x32_bf16 v[112:115], v[18:21], v[40:43], v[112:115]
    v_mfma_f32_16x16x32_bf16 v[116:119], v[18:21], v[44:47], v[116:119]
    v_mfma_f32_16x16x32_bf16 v[120:123], v[18:21], v[48:51], v[120:123]
    v_mfma_f32_16x16x32_bf16 v[124:127], v[18:21], v[52:55], v[124:127]
    ds_read_b128 v[18:21], v14 offset:3776
    s_waitcnt lgkmcnt(12)
    v_mfma_f32_16x16x32_bf16 v[116:119], v[22:25], v[32:35], v[116:119]
    v_mfma_f32_16x16x32_bf16 v[120:123], v[22:25], v[36:39], v[120:123]
    v_mfma_f32_16x16x32_bf16 v[124:127], v[22:25], v[40:43], v[124:127]
    ds_read_b128 v[22:25], v14 offset:704
    ds_read_b64 v[88:89], v15 offset:704
    ds_read_b64 v[90:91], v15 offset:712
    ds_read_b64 v[92:93], v15 offset:192
    ds_read_b64 v[94:95], v15 offset:200
    s_waitcnt lgkmcnt(15)
    v_mfma_f32_16x16x32_bf16 v[108:111], v[26:29], v[32:35], v[108:111]
    v_mfma_f32_16x16x32_bf16 v[112:115], v[26:29], v[36:39], v[112:115]
    v_mfma_f32_16x16x32_bf16 v[116:119], v[26:29], v[40:43], v[116:119]
    v_mfma_f32_16x16x32_bf16 v[120:123], v[26:29], v[44:47], v[120:123]
    v_mfma_f32_16x16x32_bf16 v[124:127], v[26:29], v[48:51], v[124:127]
    ds_read_b128 v[26:29], v14 offset:3264
    s_waitcnt lgkmcnt(12)
    v_mfma_f32_16x16x32_bf16 v[112:115], v[6:9], v[32:35], v[112:115]
    v_mfma_f32_16x16x32_bf16 v[116:119], v[6:9], v[36:39], v[116:119]
    v_mfma_f32_16x16x32_bf16 v[120:123], v[6:9], v[40:43], v[120:123]
    v_mfma_f32_16x16x32_bf16 v[124:127], v[6:9], v[44:47], v[124:127]
    ds_read_b128 v[6:9], v14 offset:1216
    s_waitcnt lgkmcnt(12)
    v_mfma_f32_16x16x32_bf16 v[96:99], v[10:13], v[64:67], v[96:99]
    v_mfma_f32_16x16x32_bf16 v[100:103], v[10:13], v[68:71], v[100:103]
    v_mfma_f32_16x16x32_bf16 v[104:107], v[10:13], v[72:75], v[104:107]
    v_mfma_f32_16x16x32_bf16 v[108:111], v[10:13], v[76:79], v[108:111]
    s_waitcnt lgkmcnt(10)
    v_mfma_f32_16x16x32_bf16 v[112:115], v[10:13], v[80:83], v[112:115]
    s_waitcnt lgkmcnt(8)
    v_mfma_f32_16x16x32_bf16 v[116:119], v[10:13], v[84:87], v[116:119]
    s_waitcnt lgkmcnt(4)
    v_mfma_f32_16x16x32_bf16 v[120:123], v[10:13], v[88:91], v[120:123]
    s_waitcnt lgkmcnt(2)
    v_mfma_f32_16x16x32_bf16 v[124:127], v[10:13], v[92:95], v[124:127]
    ds_read_b128 v[10:13], v14 offset:2752
    v_mfma_f32_16x16x32_bf16 v[124:127], v[18:21], v[64:67], v[124:127]
    ds_read_b128 v[18:21], v14 offset:1728
    v_mfma_f32_16x16x32_bf16 v[100:103], v[22:25], v[64:67], v[100:103]
    v_mfma_f32_16x16x32_bf16 v[104:107], v[22:25], v[68:71], v[104:107]
    v_mfma_f32_16x16x32_bf16 v[108:111], v[22:25], v[72:75], v[108:111]
    v_mfma_f32_16x16x32_bf16 v[112:115], v[22:25], v[76:79], v[112:115]
    v_mfma_f32_16x16x32_bf16 v[116:119], v[22:25], v[80:83], v[116:119]
    v_mfma_f32_16x16x32_bf16 v[120:123], v[22:25], v[84:87], v[120:123]
    v_mfma_f32_16x16x32_bf16 v[124:127], v[22:25], v[88:91], v[124:127]
    ds_read_b128 v[22:25], v14 offset:2240
    s_waitcnt lgkmcnt(4)
    v_mfma_f32_16x16x32_bf16 v[120:123], v[26:29], v[64:67], v[120:123]
    v_mfma_f32_16x16x32_bf16 v[124:127], v[26:29], v[68:71], v[124:127]
    s_waitcnt lgkmcnt(3)
    v_mfma_f32_16x16x32_bf16 v[104:107], v[6:9], v[64:67], v[104:107]
    v_mfma_f32_16x16x32_bf16 v[108:111], v[6:9], v[68:71], v[108:111]
    v_mfma_f32_16x16x32_bf16 v[112:115], v[6:9], v[72:75], v[112:115]
    v_mfma_f32_16x16x32_bf16 v[116:119], v[6:9], v[76:79], v[116:119]
    v_mfma_f32_16x16x32_bf16 v[120:123], v[6:9], v[80:83], v[120:123]
    v_mfma_f32_16x16x32_bf16 v[124:127], v[6:9], v[84:87], v[124:127]
    s_waitcnt lgkmcnt(2)
    v_mfma_f32_16x16x32_bf16 v[116:119], v[10:13], v[64:67], v[116:119]
    v_mfma_f32_16x16x32_bf16 v[120:123], v[10:13], v[68:71], v[120:123]
    v_mfma_f32_16x16x32_bf16 v[124:127], v[10:13], v[72:75], v[124:127]
    s_waitcnt lgkmcnt(1)
    v_mfma_f32_16x16x32_bf16 v[108:111], v[18:21], v[64:67], v[108:111]
    v_mfma_f32_16x16x32_bf16 v[112:115], v[18:21], v[68:71], v[112:115]
    v_mfma_f32_16x16x32_bf16 v[116:119], v[18:21], v[72:75], v[116:119]
    v_mfma_f32_16x16x32_bf16 v[120:123], v[18:21], v[76:79], v[120:123]
    v_mfma_f32_16x16x32_bf16 v[124:127], v[18:21], v[80:83], v[124:127]
    s_waitcnt lgkmcnt(0)
    v_mfma_f32_16x16x32_bf16 v[112:115], v[22:25], v[64:67], v[112:115]
    v_mfma_f32_16x16x32_bf16 v[116:119], v[22:25], v[68:71], v[116:119]
    v_mfma_f32_16x16x32_bf16 v[120:123], v[22:25], v[72:75], v[120:123]
    v_mfma_f32_16x16x32_bf16 v[124:127], v[22:25], v[76:79], v[124:127]
    s_nop 7
    ds_write_b128 v30, v[96:99] offset:0
    ds_write_b128 v30, v[100:103] offset:1024
    ds_write_b128 v30, v[104:107] offset:2048
    ds_write_b128 v30, v[108:111] offset:3072
    ds_write_b128 v30, v[112:115] offset:4096
    ds_write_b128 v30, v[116:119] offset:5120
    ds_write_b128 v30, v[120:123] offset:6144
    ds_write_b128 v30, v[124:127] offset:7168
    v_mov_b32 v34, 4
    ds_write_b32 v5, v34
    s_waitcnt lgkmcnt(0)
    s_endpgm
K2_LOADER:
    s_lshl_b32 s30, s23, 14
    s_sub_u32 s25, s20, 8
    s_lshl_b32 s26, s25, 11
    s_add_u32 s30, s30, s26
    v_lshlrev_b32 v4, 4, v1
    s_getpc_b64 s[62:63]
K2_PC:
    s_sub_u32 s62, s62, K2_PC - ssm_kernel
    s_subb_u32 s63, s63, 0
    v_subrev_u32 v6, 512, v0
    v_min_u32 v6, ((K2_END - ssm_kernel - 128) / 128), v6
    v_lshlrev_b32 v6, 7, v6
    s_cmp_ge_u32 s20, 10
    s_cbranch_scc1 K2_PF
    global_load_dword v7, v6, s[62:63]
K2_PF:
    s_mov_b32 s14, 2359296
    s_mov_b32 s15, 0x00020000
    s_lshl_b32 s71, s23, 3
    s_waitcnt lgkmcnt(0)
    s_load_dwordx2 s[60:61], s[52:53], s71
    s_mov_b32 s12, s54
    s_mov_b32 s13, s55
    s_barrier
    s_add_u32 s27, s30, 0
    buffer_load_dwordx4 v[32:35], v4, s[16:19], s27 offen offset:0
    buffer_load_dwordx4 v[36:39], v4, s[16:19], s27 offen offset:1024
    s_add_u32 s27, s30, 2359296
    buffer_load_dwordx4 v[40:43], v4, s[16:19], s27 offen offset:0
    buffer_load_dwordx4 v[44:47], v4, s[16:19], s27 offen offset:1024
    v_and_b32 v16, 1, v3
    v_lshlrev_b32 v16, 4, v16
    v_mov_b32 v17, 0x3f80
    v_lshlrev_b32 v16, v16, v17
    v_lshrrev_b32 v17, 1, v3
    v_lshlrev_b32 v18, 2, v2
    v_sub_u32 v17, v17, v18
    v_cmp_eq_i32 s[62:63], 0, v17
    v_cmp_eq_i32 s[64:65], 1, v17
    s_nop 0
    v_cndmask_b32 v8, 0, v16, s[62:63]
    v_cndmask_b32 v9, 0, v16, s[64:65]
    v_cmp_eq_i32 s[62:63], 2, v17
    v_cmp_eq_i32 s[64:65], 3, v17
    s_nop 0
    v_cndmask_b32 v10, 0, v16, s[62:63]
    v_cndmask_b32 v11, 0, v16, s[64:65]
    v_cmp_eq_i32 s[62:63], -8, v17
    v_cmp_eq_i32 s[64:65], -7, v17
    s_nop 0
    v_cndmask_b32 v12, 0, v16, s[62:63]
    v_cndmask_b32 v13, 0, v16, s[64:65]
    v_cmp_eq_i32 s[62:63], -6, v17
    v_cmp_eq_i32 s[64:65], -5, v17
    s_nop 0
    v_cndmask_b32 v14, 0, v16, s[62:63]
    v_cndmask_b32 v15, 0, v16, s[64:65]
    v_lshrrev_b32 v16, 1, v2
    v_and_b32 v17, 1, v2
    v_lshl_add_u32 v16, v16, 5, v17
    v_lshl_add_u32 v16, v3, 1, v16
    s_lshl_b32 s25, s25, 8
    v_add_u32 v16, s25, v16
    v_mul_u32_u24 v5, 1152, v16
    v_lshlrev_b32 v6, 2, v16
    v_add_u32 v6, 89088, v6
    s_waitcnt lgkmcnt(0)
    s_lshl_b32 s62, s60, 16
    s_and_b32 s63, s60, s28
    s_lshl_b32 s64, s61, 16
    s_and_b32 s65, s61, s28
    v_mov_b32 v16, s62
    v_mov_b32 v17, s63
    v_mov_b32 v18, s64
    v_mov_b32 v19, s65
    v_mov_b32 v20, s62
    v_mov_b32 v21, s63
    v_mov_b32 v22, s64
    v_mov_b32 v23, s65
    v_mov_b32 v24, s62
    v_mov_b32 v25, s63
    v_mov_b32 v26, s64
    v_mov_b32 v27, s65
    v_mov_b32 v28, s62
    v_mov_b32 v29, s63
    v_mov_b32 v30, s64
    v_mov_b32 v31, s65
    s_add_u32 s27, s30, 4718592
    buffer_load_dwordx4 v[48:51], v4, s[16:19], s27 offen offset:0
    buffer_load_dwordx4 v[52:55], v4, s[16:19], s27 offen offset:1024
    s_add_u32 s27, s30, 7077888
    buffer_load_dwordx4 v[56:59], v4, s[16:19], s27 offen offset:0
    buffer_load_dwordx4 v[60:63], v4, s[16:19], s27 offen offset:1024
    s_add_u32 s27, s30, 9437184
    buffer_load_dwordx4 v[64:67], v4, s[16:19], s27 offen offset:0
    buffer_load_dwordx4 v[68:71], v4, s[16:19], s27 offen offset:1024
    s_add_u32 s27, s30, 11796480
    buffer_load_dwordx4 v[72:75], v4, s[16:19], s27 offen offset:0
    buffer_load_dwordx4 v[76:79], v4, s[16:19], s27 offen offset:1024
    s_add_u32 s27, s30, 14155776
    buffer_load_dwordx4 v[80:83], v4, s[16:19], s27 offen offset:0
    buffer_load_dwordx4 v[84:87], v4, s[16:19], s27 offen offset:1024
    s_add_u32 s27, s30, 16515072
    buffer_load_dwordx4 v[88:91], v4, s[16:19], s27 offen offset:0
    buffer_load_dwordx4 v[92:95], v4, s[16:19], s27 offen offset:1024
    s_add_u32 s27, s30, 18874368
    buffer_load_dwordx4 v[96:99], v4, s[16:19], s27 offen offset:0
    buffer_load_dwordx4 v[100:103], v4, s[16:19], s27 offen offset:1024
    s_add_u32 s27, s30, 21233664
    buffer_load_dwordx4 v[104:107], v4, s[16:19], s27 offen offset:0
    buffer_load_dwordx4 v[108:111], v4, s[16:19], s27 offen offset:1024
    s_add_u32 s27, s30, 23592960
    buffer_load_dwordx4 v[112:115], v4, s[16:19], s27 offen offset:0
    buffer_load_dwordx4 v[116:119], v4, s[16:19], s27 offen offset:1024
    s_add_u32 s27, s30, 25952256
    buffer_load_dwordx4 v[120:123], v4, s[16:19], s27 offen offset:0
    buffer_load_dwordx4 v[124:127], v4, s[16:19], s27 offen offset:1024
    s_waitcnt vmcnt(23)
    v_mfma_f32_16x16x32_bf16 v[16:19], v[8:11], v[32:35], v[16:19]
    v_mfma_f32_16x16x32_bf16 v[20:23], v[12:15], v[32:35], v[20:23]
    s_add_u32 s27, s30, 28311552
    buffer_load_dwordx4 v[32:35], v4, s[16:19], s27 offen offset:0
    s_waitcnt vmcnt(23)
    v_mfma_f32_16x16x32_bf16 v[24:27], v[8:11], v[36:39], v[24:27]
    v_mfma_f32_16x16x32_bf16 v[28:31], v[12:15], v[36:39], v[28:31]
    buffer_load_dwordx4 v[36:39], v4, s[16:19], s27 offen offset:1024
    s_waitcnt vmcnt(23)
    v_mfma_f32_16x16x32_bf16 v[16:19], v[8:11], v[40:43], v[16:19]
    v_mfma_f32_16x16x32_bf16 v[20:23], v[12:15], v[40:43], v[20:23]
    s_add_u32 s27, s30, 30670848
    buffer_load_dwordx4 v[40:43], v4, s[16:19], s27 offen offset:0
    s_waitcnt vmcnt(23)
    v_mfma_f32_16x16x32_bf16 v[24:27], v[8:11], v[44:47], v[24:27]
    v_mfma_f32_16x16x32_bf16 v[28:31], v[12:15], v[44:47], v[28:31]
    buffer_load_dwordx4 v[44:47], v4, s[16:19], s27 offen offset:1024
    s_waitcnt vmcnt(23)
    v_mfma_f32_16x16x32_bf16 v[16:19], v[8:11], v[48:51], v[16:19]
    v_mfma_f32_16x16x32_bf16 v[20:23], v[12:15], v[48:51], v[20:23]
    s_add_u32 s27, s30, 33030144
    buffer_load_dwordx4 v[48:51], v4, s[16:19], s27 offen offset:0
    s_waitcnt vmcnt(23)
    v_mfma_f32_16x16x32_bf16 v[24:27], v[8:11], v[52:55], v[24:27]
    v_mfma_f32_16x16x32_bf16 v[28:31], v[12:15], v[52:55], v[28:31]
    buffer_load_dwordx4 v[52:55], v4, s[16:19], s27 offen offset:1024
    s_waitcnt vmcnt(23)
    v_mfma_f32_16x16x32_bf16 v[16:19], v[8:11], v[56:59], v[16:19]
    v_mfma_f32_16x16x32_bf16 v[20:23], v[12:15], v[56:59], v[20:23]
    s_add_u32 s27, s30, 35389440
    buffer_load_dwordx4 v[56:59], v4, s[16:19], s27 offen offset:0
    s_waitcnt vmcnt(23)
    v_mfma_f32_16x16x32_bf16 v[24:27], v[8:11], v[60:63], v[24:27]
    v_mfma_f32_16x16x32_bf16 v[28:31], v[12:15], v[60:63], v[28:31]
    buffer_load_dwordx4 v[60:63], v4, s[16:19], s27 offen offset:1024
    s_waitcnt vmcnt(23)
    v_mfma_f32_16x16x32_bf16 v[16:19], v[8:11], v[64:67], v[16:19]
    v_mfma_f32_16x16x32_bf16 v[20:23], v[12:15], v[64:67], v[20:23]
    s_add_u32 s27, s30, 37748736
    buffer_load_dwordx4 v[64:67], v4, s[16:19], s27 offen offset:0
    s_waitcnt vmcnt(23)
    v_mfma_f32_16x16x32_bf16 v[24:27], v[8:11], v[68:71], v[24:27]
    v_mfma_f32_16x16x32_bf16 v[28:31], v[12:15], v[68:71], v[28:31]
    buffer_load_dwordx4 v[68:71], v4, s[16:19], s27 offen offset:1024
    s_waitcnt vmcnt(23)
    v_mfma_f32_16x16x32_bf16 v[16:19], v[8:11], v[72:75], v[16:19]
    v_mfma_f32_16x16x32_bf16 v[20:23], v[12:15], v[72:75], v[20:23]
    s_waitcnt vmcnt(22)
    v_mfma_f32_16x16x32_bf16 v[24:27], v[8:11], v[76:79], v[24:27]
    v_mfma_f32_16x16x32_bf16 v[28:31], v[12:15], v[76:79], v[28:31]
    s_waitcnt vmcnt(21)
    v_mfma_f32_16x16x32_bf16 v[16:19], v[8:11], v[80:83], v[16:19]
    v_mfma_f32_16x16x32_bf16 v[20:23], v[12:15], v[80:83], v[20:23]
    s_waitcnt vmcnt(20)
    v_mfma_f32_16x16x32_bf16 v[24:27], v[8:11], v[84:87], v[24:27]
    v_mfma_f32_16x16x32_bf16 v[28:31], v[12:15], v[84:87], v[28:31]
    s_waitcnt vmcnt(19)
    v_mfma_f32_16x16x32_bf16 v[16:19], v[8:11], v[88:91], v[16:19]
    v_mfma_f32_16x16x32_bf16 v[20:23], v[12:15], v[88:91], v[20:23]
    s_waitcnt vmcnt(18)
    v_mfma_f32_16x16x32_bf16 v[24:27], v[8:11], v[92:95], v[24:27]
    v_mfma_f32_16x16x32_bf16 v[28:31], v[12:15], v[92:95], v[28:31]
    s_waitcnt vmcnt(17)
    v_mfma_f32_16x16x32_bf16 v[16:19], v[8:11], v[96:99], v[16:19]
    v_mfma_f32_16x16x32_bf16 v[20:23], v[12:15], v[96:99], v[20:23]
    s_waitcnt vmcnt(16)
    v_mfma_f32_16x16x32_bf16 v[24:27], v[8:11], v[100:103], v[24:27]
    v_mfma_f32_16x16x32_bf16 v[28:31], v[12:15], v[100:103], v[28:31]
    s_waitcnt vmcnt(15)
    v_mfma_f32_16x16x32_bf16 v[16:19], v[8:11], v[104:107], v[16:19]
    v_mfma_f32_16x16x32_bf16 v[20:23], v[12:15], v[104:107], v[20:23]
    s_waitcnt vmcnt(14)
    v_mfma_f32_16x16x32_bf16 v[24:27], v[8:11], v[108:111], v[24:27]
    v_mfma_f32_16x16x32_bf16 v[28:31], v[12:15], v[108:111], v[28:31]
    s_waitcnt vmcnt(13)
    v_mfma_f32_16x16x32_bf16 v[16:19], v[8:11], v[112:115], v[16:19]
    v_mfma_f32_16x16x32_bf16 v[20:23], v[12:15], v[112:115], v[20:23]
    s_waitcnt vmcnt(12)
    v_mfma_f32_16x16x32_bf16 v[24:27], v[8:11], v[116:119], v[24:27]
    v_mfma_f32_16x16x32_bf16 v[28:31], v[12:15], v[116:119], v[28:31]
    s_waitcnt vmcnt(11)
    v_mfma_f32_16x16x32_bf16 v[16:19], v[8:11], v[120:123], v[16:19]
    v_mfma_f32_16x16x32_bf16 v[20:23], v[12:15], v[120:123], v[20:23]
    s_waitcnt vmcnt(10)
    v_mfma_f32_16x16x32_bf16 v[24:27], v[8:11], v[124:127], v[24:27]
    v_mfma_f32_16x16x32_bf16 v[28:31], v[12:15], v[124:127], v[28:31]
    s_waitcnt vmcnt(9)
    v_mfma_f32_16x16x32_bf16 v[16:19], v[8:11], v[32:35], v[16:19]
    v_mfma_f32_16x16x32_bf16 v[20:23], v[12:15], v[32:35], v[20:23]
    s_waitcnt vmcnt(8)
    v_mfma_f32_16x16x32_bf16 v[24:27], v[8:11], v[36:39], v[24:27]
    v_mfma_f32_16x16x32_bf16 v[28:31], v[12:15], v[36:39], v[28:31]
    s_waitcnt vmcnt(7)
    v_mfma_f32_16x16x32_bf16 v[16:19], v[8:11], v[40:43], v[16:19]
    v_mfma_f32_16x16x32_bf16 v[20:23], v[12:15], v[40:43], v[20:23]
    s_waitcnt vmcnt(6)
    v_mfma_f32_16x16x32_bf16 v[24:27], v[8:11], v[44:47], v[24:27]
    v_mfma_f32_16x16x32_bf16 v[28:31], v[12:15], v[44:47], v[28:31]
    s_waitcnt vmcnt(5)
    v_mfma_f32_16x16x32_bf16 v[16:19], v[8:11], v[48:51], v[16:19]
    v_mfma_f32_16x16x32_bf16 v[20:23], v[12:15], v[48:51], v[20:23]
    s_waitcnt vmcnt(4)
    v_mfma_f32_16x16x32_bf16 v[24:27], v[8:11], v[52:55], v[24:27]
    v_mfma_f32_16x16x32_bf16 v[28:31], v[12:15], v[52:55], v[28:31]
    s_waitcnt vmcnt(3)
    v_mfma_f32_16x16x32_bf16 v[16:19], v[8:11], v[56:59], v[16:19]
    v_mfma_f32_16x16x32_bf16 v[20:23], v[12:15], v[56:59], v[20:23]
    s_waitcnt vmcnt(2)
    v_mfma_f32_16x16x32_bf16 v[24:27], v[8:11], v[60:63], v[24:27]
    v_mfma_f32_16x16x32_bf16 v[28:31], v[12:15], v[60:63], v[28:31]
    s_waitcnt vmcnt(1)
    v_mfma_f32_16x16x32_bf16 v[16:19], v[8:11], v[64:67], v[16:19]
    v_mfma_f32_16x16x32_bf16 v[20:23], v[12:15], v[64:67], v[20:23]
    s_waitcnt vmcnt(0)
    v_mfma_f32_16x16x32_bf16 v[24:27], v[8:11], v[68:71], v[24:27]
    v_mfma_f32_16x16x32_bf16 v[28:31], v[12:15], v[68:71], v[28:31]
    v_and_b32 v7, 7, v1
    v_lshlrev_b32 v7, 2, v7
    v_add_u32 v7, 160768, v7
K2_FW:
    ds_read_b32 v4, v7
    s_waitcnt lgkmcnt(0)
    v_cmp_gt_u32 vcc, 4, v4
    s_nop 4
    s_cbranch_vccz K2_FD
    s_sleep 2
    s_branch K2_FW
K2_FD:
    ds_read2st64_b32 v[32:33], v6 offset0:0 offset1:1
    ds_read2st64_b32 v[34:35], v6 offset0:32 offset1:33
    ds_read2st64_b32 v[36:37], v6 offset0:64 offset1:65
    ds_read2st64_b32 v[38:39], v6 offset0:96 offset1:97
    ds_read2st64_b32 v[40:41], v6 offset0:128 offset1:129
    ds_read2st64_b32 v[42:43], v6 offset0:160 offset1:161
    ds_read2st64_b32 v[44:45], v6 offset0:192 offset1:193
    ds_read2st64_b32 v[46:47], v6 offset0:224 offset1:225
    ds_read2st64_b32 v[48:49], v6 offset0:2 offset1:3
    ds_read2st64_b32 v[50:51], v6 offset0:34 offset1:35
    ds_read2st64_b32 v[52:53], v6 offset0:66 offset1:67
    ds_read2st64_b32 v[54:55], v6 offset0:98 offset1:99
    ds_read2st64_b32 v[56:57], v6 offset0:130 offset1:131
    ds_read2st64_b32 v[58:59], v6 offset0:162 offset1:163
    ds_read2st64_b32 v[60:61], v6 offset0:194 offset1:195
    ds_read2st64_b32 v[62:63], v6 offset0:226 offset1:227
    s_waitcnt lgkmcnt(8)
    v_add_f32 v32, v32, v34
    v_add_f32 v36, v36, v38
    v_add_f32 v40, v40, v42
    v_add_f32 v44, v44, v46
    v_add_f32 v32, v32, v16
    v_add_f32 v36, v36, v17
    v_add_f32 v40, v40, v18
    v_add_f32 v44, v44, v19
    v_cvt_pk_bf16_f32 v64, v32, v36
    v_cvt_pk_bf16_f32 v65, v40, v44
    s_add_u32 s72, s71, 0
    buffer_store_dwordx2 v[64:65], v5, s[12:15], s72 offen
    v_add_f32 v33, v33, v35
    v_add_f32 v37, v37, v39
    v_add_f32 v41, v41, v43
    v_add_f32 v45, v45, v47
    v_add_f32 v33, v33, v20
    v_add_f32 v37, v37, v21
    v_add_f32 v41, v41, v22
    v_add_f32 v45, v45, v23
    v_cvt_pk_bf16_f32 v66, v33, v37
    v_cvt_pk_bf16_f32 v67, v41, v45
    s_add_u32 s72, s71, 73728
    buffer_store_dwordx2 v[66:67], v5, s[12:15], s72 offen
    s_waitcnt lgkmcnt(0)
    v_add_f32 v48, v48, v50
    v_add_f32 v52, v52, v54
    v_add_f32 v56, v56, v58
    v_add_f32 v60, v60, v62
    v_add_f32 v48, v48, v24
    v_add_f32 v52, v52, v25
    v_add_f32 v56, v56, v26
    v_add_f32 v60, v60, v27
    v_cvt_pk_bf16_f32 v68, v48, v52
    v_cvt_pk_bf16_f32 v69, v56, v60
    s_add_u32 s72, s71, 147456
    buffer_store_dwordx2 v[68:69], v5, s[12:15], s72 offen
    v_add_f32 v49, v49, v51
    v_add_f32 v53, v53, v55
    v_add_f32 v57, v57, v59
    v_add_f32 v61, v61, v63
    v_add_f32 v49, v49, v28
    v_add_f32 v53, v53, v29
    v_add_f32 v57, v57, v30
    v_add_f32 v61, v61, v31
    v_cvt_pk_bf16_f32 v70, v49, v53
    v_cvt_pk_bf16_f32 v71, v57, v61
    s_add_u32 s72, s71, 221184
    buffer_store_dwordx2 v[70:71], v5, s[12:15], s72 offen
K2_END:
    s_endpgm
.section .rodata,"a"
.p2align 6
.amdhsa_kernel mlp_kernel
  .amdhsa_next_free_vgpr 256
  .amdhsa_next_free_sgpr 102
  .amdhsa_accum_offset 256
  .amdhsa_group_segment_fixed_size 0
  .amdhsa_kernarg_size 136
  .amdhsa_user_sgpr_count 2
  .amdhsa_user_sgpr_kernarg_segment_ptr 1
  .amdhsa_system_sgpr_workgroup_id_x 1
  .amdhsa_float_denorm_mode_32 3
.end_amdhsa_kernel
.section .rodata,"a"
.p2align 6
.amdhsa_kernel ssm_kernel
  .amdhsa_next_free_vgpr 128
  .amdhsa_next_free_sgpr 102
  .amdhsa_accum_offset 128
  .amdhsa_group_segment_fixed_size 0
  .amdhsa_kernarg_size 136
  .amdhsa_user_sgpr_count 2
  .amdhsa_user_sgpr_kernarg_segment_ptr 1
  .amdhsa_system_sgpr_workgroup_id_x 1
  .amdhsa_float_denorm_mode_32 3
.end_amdhsa_kernel
```
